```python
import torch

def _softmax(x, axis=-1):
    return torch.softmax(x, dim=axis)
def _gelu(x):
    return torch.nn.functional.gelu(x, approximate="tanh")
def _silu(x):
    return torch.nn.functional.silu(x)
def _sigmoid(x):
    return torch.sigmoid(x)
def _layernorm(x, axis=-1, eps=1e-5):
    m = x.mean(dim=axis, keepdim=True)
    v = x.var(dim=axis, keepdim=True, unbiased=False)
    return (x - m) / torch.sqrt(v + eps)
def _scatter_add(tgt, idx, src, axis=0):
    return tgt.clone().index_add_(axis, idx, src)
def _segment_sum(src, seg, n):
    out = torch.zeros((n,) + src.shape[1:], dtype=src.dtype)
    return out.index_add_(0, seg, src)
def _pad(x, pw):
    flat = tuple(v for pair in reversed(pw) for v in pair)
    return torch.nn.functional.pad(x, flat)

kernel_name = 'standalone__detection_seg_dino__vision'

def setup_inputs():

    _w = (lambda a: (lambda t: t.to(torch.bfloat16) if t.is_floating_point() else t)(torch.as_tensor(a)))
    H = W = (224 // 2) * 2
    C = 192
    Nq = 16
    sc = C ** -0.5
    return {
        "q": _w((lambda *s: torch.randn(*s, dtype=torch.bfloat16) * 0.05)(1, Nq, C)),
        "f0": _w((lambda *s: torch.randn(*s, dtype=torch.bfloat16) * 0.8)(1, H, W, C)),
        "f1": _w((lambda *s: torch.randn(*s, dtype=torch.bfloat16) * 0.8)(1, H // 2, W // 2, C)),
        "wq": _w((lambda *s: torch.randn(*s, dtype=torch.bfloat16) * 1.6)(C, C) * sc),
        "wk": _w((lambda *s: torch.randn(*s, dtype=torch.bfloat16) * 1.6)(C, C) * sc),
        "wv": _w((lambda *s: torch.randn(*s, dtype=torch.bfloat16) * 0.8)(C, C) * sc),
        "wo": _w((lambda *s: torch.randn(*s, dtype=torch.bfloat16) * 0.8)(C, C) * sc),
    }

def reference(q, f0, f1, wq, wk, wv, wo):
    B, H, W, C = f0.shape
    f1u = (lambda x, n, axis: torch.repeat_interleave(x, n, dim=axis))((lambda x, n, axis: torch.repeat_interleave(x, n, dim=axis))(f1, 2, axis=1), 2, axis=2)
    fused = f0 + f1u
    feats = _layernorm(fused.reshape(B, H * W, C), axis=-1)
    qn = _layernorm(q, axis=-1)
    Q = torch.einsum("bnc,cd->bnd", qn, wq)
    K = torch.einsum("bmc,cd->bmd", feats, wk)
    V = torch.einsum("bmc,cd->bmd", feats, wv)
    scale = C ** -0.5
    logits = torch.einsum("bnd,bmd->bnm", Q, K) * scale
    attn = _softmax(logits, axis=-1)
    ctx = torch.einsum("bnm,bmd->bnd", attn, V)
    return q + torch.einsum("bnd,dc->bnc", ctx, wo)
```

```asm
; @launch grid=(248,1,1) block=(1024,1,1) lds=134144
.amdgcn_target "amdgcn-amd-amdhsa--gfx950"
.text
.globl standalone__detection_seg_dino__vision_kernel
.p2align 8
.type standalone__detection_seg_dino__vision_kernel,@function
standalone__detection_seg_dino__vision_kernel:
    s_cmp_ge_u32 s2, 248
    s_cbranch_scc1 L_main_end
    s_memrealtime s[64:65]
    s_load_dwordx16 s[4:19], s[0:1], 0
    s_load_dwordx4 s[20:23], s[0:1], 64
    v_lshrrev_b32 v2, 6, v0
    v_and_b32 v1, 63, v0
    v_readfirstlane_b32 s3, v2
    s_and_b32 s94, s2, 7
    s_lshr_b32 s95, s2, 3
    s_sub_u32 s33, s2, 24
    s_cmp_ge_u32 s2, 48
    s_nop 0
    s_cbranch_scc1 L_stream
    s_cmp_lt_u32 s94, 2
    s_cbranch_scc1 L_prod
    s_cmp_lt_u32 s95, 2
    s_cbranch_scc1 L_wvo
    s_lshl_b32 s33, s95, 1
    s_sub_u32 s33, s2, s33
    s_sub_u32 s33, s33, 14
L_stream:
    s_mov_b32 s55, 4
    s_cmp_ge_u32 s3, 14
    s_cbranch_scc1 L_s_helper
    v_lshrrev_b32 v4, 3, v1
    v_and_b32 v5, 7, v1
    v_and_b32 v6, 6, v4
    v_xor_b32 v6, v6, v5
    v_lshlrev_b32 v20, 4, v6
    v_lshrrev_b32 v6, 5, v1
    v_mul_u32_u24 v6, 768, v6
    v_add_u32 v20, v20, v6
    v_bfe_u32 v6, v1, 4, 1
    v_mul_u32_u24 v6, 86016, v6
    v_add_u32 v20, v20, v6
    v_bfe_u32 v6, v1, 3, 1
    v_mul_u32_u24 v6, 384, v6
    v_add_u32 v20, v20, v6
    s_and_b32 s46, s3, 3
    s_lshl_b32 s46, s46, 1
    v_xor_b32 v6, s46, v5
    v_lshlrev_b32 v21, 4, v6
    v_and_b32 v6, 3, v4
    v_mul_u32_u24 v6, 384, v6
    v_add_u32 v21, v21, v6
    v_lshrrev_b32 v6, 5, v1
    v_lshl_add_u32 v22, v6, 7, v21
    s_lshr_b32 s40, s33, 1
    s_mul_i32 s40, s40, 172032
    s_and_b32 s41, s33, 1
    s_mul_i32 s41, s41, 43008
    s_add_u32 s40, s40, s41
    s_mul_i32 s41, s3, 3072
    s_add_u32 s40, s40, s41
    s_mul_i32 s43, s33, 21504
    s_mul_i32 s41, s3, 1536
    s_add_u32 s43, s43, s41
    s_mul_i32 s44, s3, 6144
    s_add_u32 s44, s44, 48128
    s_add_u32 s45, s41, 26624
    v_mov_b32 v7, 0
    s_waitcnt lgkmcnt(0)
    s_mov_b32 s24, s6
    s_mov_b32 s25, s7
    s_mov_b32 s26, 19267584
    s_mov_b32 s27, 0x20000
    s_mov_b32 s28, s8
    s_mov_b32 s29, s9
    s_mov_b32 s30, 4816896
    s_mov_b32 s31, 0x20000
    s_cmp_lg_u32 s3, 0
    s_cbranch_scc1 L_s_nopf
    s_cmp_ge_u32 s94, 2
    s_cbranch_scc1 L_s_nopf
    s_sub_u32 s41, s95, 6
    s_cmp_ge_u32 s41, 24
    s_cbranch_scc1 L_s_nopf
    s_mul_i32 s41, s41, 3072
    s_mov_b32 s36, s10
    s_mov_b32 s37, s11
    s_mov_b32 s38, 73728
    s_mov_b32 s39, 0x20000
    v_lshlrev_b32 v8, 4, v1
    buffer_load_dwordx4 v[24:27], v8, s[36:39], s41 offen offset:0
    buffer_load_dwordx4 v[28:31], v8, s[36:39], s41 offen offset:1024
    buffer_load_dwordx4 v[32:35], v8, s[36:39], s41 offen offset:2048
L_s_nopf:
    s_cmp_lt_u32 s3, 4
    s_cbranch_scc1 L_s_issue
    s_barrier
    s_sub_u32 s54, s3, 3
    s_mov_b32 s62, 0
L_sp1:
    ds_read_b32 v18, v7 offset:18180
    s_add_u32 s62, s62, 1
    s_waitcnt lgkmcnt(0)
    v_readfirstlane_b32 s60, v18
    s_nop 0
    s_cmp_ge_u32 s60, s54
    s_nop 2
    s_cbranch_scc1 L_sp1_d
    s_cmp_gt_u32 s62, 0x1000000
    s_cbranch_scc1 L_sp1_d
    s_sleep 1
    s_branch L_sp1
L_sp1_d:
L_s_issue:
    s_mov_b32 m0, s45
    s_nop 0
    buffer_load_dwordx4 v22, s[28:31], s43 offen nt lds
    s_add_u32 m0, s44, 0
    s_add_u32 s41, s40, 0
    buffer_load_dwordx4 v20, s[24:27], s41 offen nt lds
    s_add_u32 m0, s44, 1024
    s_add_u32 s41, s40, 1536
    buffer_load_dwordx4 v20, s[24:27], s41 offen nt lds
    s_add_u32 m0, s44, 2048
    s_add_u32 s41, s40, 128
    buffer_load_dwordx4 v20, s[24:27], s41 offen nt lds
    s_add_u32 m0, s44, 3072
    s_add_u32 s41, s40, 1664
    buffer_load_dwordx4 v20, s[24:27], s41 offen nt lds
    s_add_u32 m0, s45, 1024
    s_add_u32 s41, s43, 256
    s_mov_b32 exec_hi, 0
    buffer_load_dwordx4 v21, s[28:31], s41 offen nt lds
    s_mov_b64 exec, -1
    s_add_u32 m0, s44, 4096
    s_add_u32 s41, s40, 256
    buffer_load_dwordx4 v20, s[24:27], s41 offen nt lds
    s_add_u32 m0, s44, 5120
    s_add_u32 s41, s40, 1792
    buffer_load_dwordx4 v20, s[24:27], s41 offen nt lds
    s_cmp_lt_u32 s3, 4
    s_cbranch_scc0 L_s_nob0
    s_barrier
L_s_nob0:
    s_add_u32 s96, s22, 1048576
    s_addc_u32 s97, s23, 0
    s_mov_b32 s98, 2752512
    s_mov_b32 s99, 0x20000
    s_mov_b64 s[82:83], s[4:5]
    s_mov_b64 s[100:101], s[18:19]
    v_and_b32 v2, 15, v1
    v_lshrrev_b32 v3, 4, v1
    v_lshlrev_b32 v4, 7, v2
    v_add_u32 v4, s44, v4
    v_and_b32 v5, 2, v2
    v_xor_b32 v5, v5, v3
    v_lshl_add_u32 v4, v5, 4, v4
    v_and_b32 v5, 4, v2
    v_lshlrev_b32 v5, 4, v5
    v_add_u32 v14, v4, v5
    v_xor_b32 v5, 64, v5
    v_add_u32 v15, v4, v5
    v_lshrrev_b32 v4, 2, v2
    v_lshlrev_b32 v4, 7, v4
    v_add_u32 v4, s45, v4
    s_and_b32 s47, s46, 2
    s_and_b32 s48, s46, 4
    s_lshl_b32 s48, s48, 4
    v_xor_b32 v5, s47, v3
    v_lshl_add_u32 v4, v5, 4, v4
    v_add_u32 v16, s48, v4
    s_xor_b32 s48, s48, 64
    v_add_u32 v17, s48, v4
    v_lshlrev_b32 v8, 4, v1
    v_mov_b32 v9, 1.0
    s_mov_b32 s50, 0x3f803f80
    s_lshr_b32 s51, s3, 1
    s_lshl_b32 s51, s51, 10
    s_and_b32 s52, s3, 1
    s_lshl_b32 s52, s52, 3
    s_add_u32 s51, s51, s52
    v_add_u32 v4, s51, v8
    v_bfe_u32 v100, v1, 2, 4
    v_lshlrev_b32 v101, 7, v100
    v_and_b32 v102, 6, v100
    v_bfe_u32 v103, v1, 1, 1
    s_mov_b32 s89, s3
    s_and_b32 s51, s3, 3
    s_lshl_b32 s51, s51, 1
    v_add_u32 v103, s51, v103
    v_xor_b32 v102, v102, v103
    v_lshl_add_u32 v101, v102, 4, v101
    v_and_b32 v102, 1, v1
    v_lshl_add_u32 v5, v102, 3, v101
    s_lshr_b32 s51, s3, 2
    s_lshl_b32 s51, s51, 11
    s_add_u32 s51, s51, 48128
    v_add_u32 v5, s51, v5
    v_mul_u32_u24 v11, 80, v2
    s_lshl_b32 s51, s3, 2
    v_add_u32 v6, s51, v11
    v_lshlrev_b32 v10, 2, v2
    v_mov_b32 v12, 1
    s_lshl_b32 s51, 1, s3
    v_mov_b32 v13, s51
    s_mov_b32 s49, 0x3baaaaab
    s_nop 0
L_tile:
    s_cmp_ge_u32 s3, 12
    s_cbranch_scc1 L_pr3
    s_cmp_ge_u32 s3, 8
    s_cbranch_scc1 L_pr1
    s_setprio 2
    s_branch L_prd
L_pr1:
    s_setprio 1
    s_branch L_prd
L_pr3:
    s_setprio 3
L_prd:
    v_mov_b32 v19, 0x3727c5ac
    v_mov_b32 v112, s50
    v_mov_b32 v113, s50
    v_mov_b32 v114, s50
    v_mov_b32 v115, s50
    s_mov_b32 s52, 0x00003f80
    s_mov_b32 s53, 0x3f800000
    s_mov_b32 s54, 0
    s_mov_b32 s36, s22
    s_mov_b32 s37, s23
    s_mov_b32 s38, 1048576
    s_mov_b32 s39, 0x20000
    s_waitcnt vmcnt(5)
    s_cmp_eq_u32 s55, 14
    s_cbranch_scc1 L_tile_nosig
    s_mov_b64 exec, 1
    ds_add_u32 v7, v12 offset:18180
    s_mov_b64 exec, -1
L_tile_nosig:
    ds_read_b32 v18, v7 offset:18176
    s_waitcnt lgkmcnt(0)
    v_readfirstlane_b32 s60, v18
    s_nop 0
    s_cmp_ge_u32 s60, 6
    s_nop 2
    s_cbranch_scc1 L_tile_late
    v_mov_b32 v116, 0
    v_mov_b32 v117, 0
    s_waitcnt vmcnt(5)
    ds_read_b128 v[44:47], v14 offset:0
    ds_read_b128 v[48:51], v16 offset:0
    ds_read_b128 v[52:55], v15 offset:0
    ds_read_b128 v[56:59], v17 offset:0
    s_waitcnt lgkmcnt(2)
    v_lshlrev_b32 v60, 16, v48
    v_and_b32 v61, 0xffff0000, v48
    v_lshlrev_b32 v62, 16, v49
    v_and_b32 v63, 0xffff0000, v49
    v_lshlrev_b32 v64, 16, v50
    v_and_b32 v65, 0xffff0000, v50
    v_lshlrev_b32 v66, 16, v51
    v_and_b32 v67, 0xffff0000, v51
    v_dot2_f32_bf16 v60, v44, s52, v60
    v_dot2_f32_bf16 v61, v44, s53, v61
    v_dot2_f32_bf16 v62, v45, s52, v62
    v_dot2_f32_bf16 v63, v45, s53, v63
    v_dot2_f32_bf16 v64, v46, s52, v64
    v_dot2_f32_bf16 v65, v46, s53, v65
    v_dot2_f32_bf16 v66, v47, s52, v66
    v_dot2_f32_bf16 v67, v47, s53, v67
    v_cvt_pk_bf16_f32 v20, v60, v61
    v_cvt_pk_bf16_f32 v21, v62, v63
    v_cvt_pk_bf16_f32 v22, v64, v65
    v_cvt_pk_bf16_f32 v23, v66, v67
    ds_write_b128 v14, v[20:23] offset:0
    s_nop 0
    v_mfma_f32_16x16x32_bf16 v[104:107], v[20:23], v[112:115], 0
    v_dot2_f32_bf16 v116, v20, v20, v116
    v_dot2_f32_bf16 v117, v21, v21, v117
    v_dot2_f32_bf16 v116, v22, v22, v116
    v_dot2_f32_bf16 v117, v23, v23, v117
    s_waitcnt lgkmcnt(1)
    v_lshlrev_b32 v60, 16, v56
    v_and_b32 v61, 0xffff0000, v56
    v_lshlrev_b32 v62, 16, v57
    v_and_b32 v63, 0xffff0000, v57
    v_lshlrev_b32 v64, 16, v58
    v_and_b32 v65, 0xffff0000, v58
    v_lshlrev_b32 v66, 16, v59
    v_and_b32 v67, 0xffff0000, v59
    v_dot2_f32_bf16 v60, v52, s52, v60
    v_dot2_f32_bf16 v61, v52, s53, v61
    v_dot2_f32_bf16 v62, v53, s52, v62
    v_dot2_f32_bf16 v63, v53, s53, v63
    v_dot2_f32_bf16 v64, v54, s52, v64
    v_dot2_f32_bf16 v65, v54, s53, v65
    v_dot2_f32_bf16 v66, v55, s52, v66
    v_dot2_f32_bf16 v67, v55, s53, v67
    v_cvt_pk_bf16_f32 v24, v60, v61
    v_cvt_pk_bf16_f32 v25, v62, v63
    v_cvt_pk_bf16_f32 v26, v64, v65
    v_cvt_pk_bf16_f32 v27, v66, v67
    ds_write_b128 v15, v[24:27] offset:0
    s_nop 0
    v_mfma_f32_16x16x32_bf16 v[104:107], v[24:27], v[112:115], v[104:107]
    v_dot2_f32_bf16 v116, v24, v24, v116
    v_dot2_f32_bf16 v117, v25, v25, v117
    v_dot2_f32_bf16 v116, v26, v26, v116
    v_dot2_f32_bf16 v117, v27, v27, v117
    s_waitcnt vmcnt(3)
    ds_read_b128 v[44:47], v14 offset:2048
    ds_read_b128 v[48:51], v16 offset:512
    ds_read_b128 v[52:55], v15 offset:2048
    ds_read_b128 v[56:59], v17 offset:512
    s_waitcnt lgkmcnt(2)
    v_lshlrev_b32 v60, 16, v48
    v_and_b32 v61, 0xffff0000, v48
    v_lshlrev_b32 v62, 16, v49
    v_and_b32 v63, 0xffff0000, v49
    v_lshlrev_b32 v64, 16, v50
    v_and_b32 v65, 0xffff0000, v50
    v_lshlrev_b32 v66, 16, v51
    v_and_b32 v67, 0xffff0000, v51
    v_dot2_f32_bf16 v60, v44, s52, v60
    v_dot2_f32_bf16 v61, v44, s53, v61
    v_dot2_f32_bf16 v62, v45, s52, v62
    v_dot2_f32_bf16 v63, v45, s53, v63
    v_dot2_f32_bf16 v64, v46, s52, v64
    v_dot2_f32_bf16 v65, v46, s53, v65
    v_dot2_f32_bf16 v66, v47, s52, v66
    v_dot2_f32_bf16 v67, v47, s53, v67
    v_cvt_pk_bf16_f32 v28, v60, v61
    v_cvt_pk_bf16_f32 v29, v62, v63
    v_cvt_pk_bf16_f32 v30, v64, v65
    v_cvt_pk_bf16_f32 v31, v66, v67
    ds_write_b128 v14, v[28:31] offset:2048
    s_nop 0
    v_mfma_f32_16x16x32_bf16 v[104:107], v[28:31], v[112:115], v[104:107]
    v_dot2_f32_bf16 v116, v28, v28, v116
    v_dot2_f32_bf16 v117, v29, v29, v117
    v_dot2_f32_bf16 v116, v30, v30, v116
    v_dot2_f32_bf16 v117, v31, v31, v117
    s_waitcnt lgkmcnt(1)
    v_lshlrev_b32 v60, 16, v56
    v_and_b32 v61, 0xffff0000, v56
    v_lshlrev_b32 v62, 16, v57
    v_and_b32 v63, 0xffff0000, v57
    v_lshlrev_b32 v64, 16, v58
    v_and_b32 v65, 0xffff0000, v58
    v_lshlrev_b32 v66, 16, v59
    v_and_b32 v67, 0xffff0000, v59
    v_dot2_f32_bf16 v60, v52, s52, v60
    v_dot2_f32_bf16 v61, v52, s53, v61
    v_dot2_f32_bf16 v62, v53, s52, v62
    v_dot2_f32_bf16 v63, v53, s53, v63
    v_dot2_f32_bf16 v64, v54, s52, v64
    v_dot2_f32_bf16 v65, v54, s53, v65
    v_dot2_f32_bf16 v66, v55, s52, v66
    v_dot2_f32_bf16 v67, v55, s53, v67
    v_cvt_pk_bf16_f32 v32, v60, v61
    v_cvt_pk_bf16_f32 v33, v62, v63
    v_cvt_pk_bf16_f32 v34, v64, v65
    v_cvt_pk_bf16_f32 v35, v66, v67
    ds_write_b128 v15, v[32:35] offset:2048
    s_nop 0
    v_mfma_f32_16x16x32_bf16 v[104:107], v[32:35], v[112:115], v[104:107]
    v_dot2_f32_bf16 v116, v32, v32, v116
    v_dot2_f32_bf16 v117, v33, v33, v117
    v_dot2_f32_bf16 v116, v34, v34, v116
    v_dot2_f32_bf16 v117, v35, v35, v117
    s_waitcnt vmcnt(0)
    ds_read_b128 v[44:47], v14 offset:4096
    ds_read_b128 v[48:51], v16 offset:1024
    ds_read_b128 v[52:55], v15 offset:4096
    ds_read_b128 v[56:59], v17 offset:1024
    s_waitcnt lgkmcnt(2)
    v_lshlrev_b32 v60, 16, v48
    v_and_b32 v61, 0xffff0000, v48
    v_lshlrev_b32 v62, 16, v49
    v_and_b32 v63, 0xffff0000, v49
    v_lshlrev_b32 v64, 16, v50
    v_and_b32 v65, 0xffff0000, v50
    v_lshlrev_b32 v66, 16, v51
    v_and_b32 v67, 0xffff0000, v51
    v_dot2_f32_bf16 v60, v44, s52, v60
    v_dot2_f32_bf16 v61, v44, s53, v61
    v_dot2_f32_bf16 v62, v45, s52, v62
    v_dot2_f32_bf16 v63, v45, s53, v63
    v_dot2_f32_bf16 v64, v46, s52, v64
    v_dot2_f32_bf16 v65, v46, s53, v65
    v_dot2_f32_bf16 v66, v47, s52, v66
    v_dot2_f32_bf16 v67, v47, s53, v67
    v_cvt_pk_bf16_f32 v36, v60, v61
    v_cvt_pk_bf16_f32 v37, v62, v63
    v_cvt_pk_bf16_f32 v38, v64, v65
    v_cvt_pk_bf16_f32 v39, v66, v67
    ds_write_b128 v14, v[36:39] offset:4096
    s_nop 0
    v_mfma_f32_16x16x32_bf16 v[104:107], v[36:39], v[112:115], v[104:107]
    v_dot2_f32_bf16 v116, v36, v36, v116
    v_dot2_f32_bf16 v117, v37, v37, v117
    v_dot2_f32_bf16 v116, v38, v38, v116
    v_dot2_f32_bf16 v117, v39, v39, v117
    s_waitcnt lgkmcnt(1)
    v_lshlrev_b32 v60, 16, v56
    v_and_b32 v61, 0xffff0000, v56
    v_lshlrev_b32 v62, 16, v57
    v_and_b32 v63, 0xffff0000, v57
    v_lshlrev_b32 v64, 16, v58
    v_and_b32 v65, 0xffff0000, v58
    v_lshlrev_b32 v66, 16, v59
    v_and_b32 v67, 0xffff0000, v59
    v_dot2_f32_bf16 v60, v52, s52, v60
    v_dot2_f32_bf16 v61, v52, s53, v61
    v_dot2_f32_bf16 v62, v53, s52, v62
    v_dot2_f32_bf16 v63, v53, s53, v63
    v_dot2_f32_bf16 v64, v54, s52, v64
    v_dot2_f32_bf16 v65, v54, s53, v65
    v_dot2_f32_bf16 v66, v55, s52, v66
    v_dot2_f32_bf16 v67, v55, s53, v67
    v_cvt_pk_bf16_f32 v40, v60, v61
    v_cvt_pk_bf16_f32 v41, v62, v63
    v_cvt_pk_bf16_f32 v42, v64, v65
    v_cvt_pk_bf16_f32 v43, v66, v67
    ds_write_b128 v15, v[40:43] offset:4096
    s_nop 0
    v_mfma_f32_16x16x32_bf16 v[104:107], v[40:43], v[112:115], v[104:107]
    v_dot2_f32_bf16 v116, v40, v40, v116
    v_dot2_f32_bf16 v117, v41, v41, v117
    v_dot2_f32_bf16 v116, v42, v42, v116
    v_dot2_f32_bf16 v117, v43, v43, v117
    s_cmp_eq_u32 s55, 14
    s_nop 6
    s_cbranch_scc1 L_sig0
    s_mov_b64 exec, 1
    ds_add_u32 v7, v12 offset:18200
    s_mov_b64 exec, -1
L_sig0:
    v_add_f32 v116, v116, v117
    s_nop 1
    v_mfma_f32_16x16x4_f32 v[72:75], v116, v9, 0
    v_mul_f32 v68, s49, v104
    v_mul_f32 v69, s49, v105
    v_mul_f32 v70, s49, v106
    v_mul_f32 v71, s49, v107
    s_nop 5
    v_fma_f32 v72, v72, s49, v19
    v_fma_f32 v73, v73, s49, v19
    v_fma_f32 v74, v74, s49, v19
    v_fma_f32 v75, v75, s49, v19
    v_fma_f32 v72, -v68, v68, v72
    v_fma_f32 v73, -v69, v69, v73
    v_fma_f32 v74, -v70, v70, v74
    v_fma_f32 v75, -v71, v71, v75
    v_max_f32 v72, v72, v19
    v_max_f32 v73, v73, v19
    v_max_f32 v74, v74, v19
    v_max_f32 v75, v75, v19
    v_rsq_f32 v72, v72
    v_rsq_f32 v73, v73
    v_rsq_f32 v74, v74
    v_rsq_f32 v75, v75
    s_cmp_eq_u32 s55, 14
    s_nop 0
    s_cbranch_scc1 L_tile_nocomb
    s_cmp_ge_u32 s3, 8
    s_cbranch_scc1 L_tile_nocomb
    s_cmp_ge_u32 s3, 6
    s_cbranch_scc0 L_tile_comb
    s_lshl_b32 s51, s33, 2
    s_add_u32 s51, s51, s3
    s_sub_u32 s51, s51, 4
    s_and_b32 s51, s51, 127
    s_lshl_b32 s34, s51, 8
    s_add_u32 s34, s34, 65536
    s_add_u32 s56, s22, s34
    s_addc_u32 s57, s23, 0
    s_mov_b32 s35, 0
L_s67_pl:
    s_add_u32 s35, s35, 1
    s_load_dwordx16 s[4:19], s[56:57], 0 glc
    s_load_dwordx8 s[24:31], s[56:57], 64 glc
    ds_read_b32 v18, v7 offset:18188
    s_waitcnt lgkmcnt(0)
    v_readfirstlane_b32 s48, v18
    s_nop 0
    s_cmp_lg_u32 s48, 0
    s_nop 2
    s_cbranch_scc1 L_tile_nocomb
    s_mov_b32 s48, 0
    s_sub_u32 s40, s4, s64
    s_subb_u32 s41, s5, s65
    s_add_u32 s40, s40, 0x100000
    s_addc_u32 s41, s41, 0
    s_lshr_b32 s40, s40, 25
    s_or_b32 s40, s40, s41
    s_or_b32 s48, s48, s40
    s_sub_u32 s40, s6, s64
    s_subb_u32 s41, s7, s65
    s_add_u32 s40, s40, 0x100000
    s_addc_u32 s41, s41, 0
    s_lshr_b32 s40, s40, 25
    s_or_b32 s40, s40, s41
    s_or_b32 s48, s48, s40
    s_sub_u32 s40, s8, s64
    s_subb_u32 s41, s9, s65
    s_add_u32 s40, s40, 0x100000
    s_addc_u32 s41, s41, 0
    s_lshr_b32 s40, s40, 25
    s_or_b32 s40, s40, s41
    s_or_b32 s48, s48, s40
    s_sub_u32 s40, s10, s64
    s_subb_u32 s41, s11, s65
    s_add_u32 s40, s40, 0x100000
    s_addc_u32 s41, s41, 0
    s_lshr_b32 s40, s40, 25
    s_or_b32 s40, s40, s41
    s_or_b32 s48, s48, s40
    s_sub_u32 s40, s12, s64
    s_subb_u32 s41, s13, s65
    s_add_u32 s40, s40, 0x100000
    s_addc_u32 s41, s41, 0
    s_lshr_b32 s40, s40, 25
    s_or_b32 s40, s40, s41
    s_or_b32 s48, s48, s40
    s_sub_u32 s40, s14, s64
    s_subb_u32 s41, s15, s65
    s_add_u32 s40, s40, 0x100000
    s_addc_u32 s41, s41, 0
    s_lshr_b32 s40, s40, 25
    s_or_b32 s40, s40, s41
    s_or_b32 s48, s48, s40
    s_sub_u32 s40, s16, s64
    s_subb_u32 s41, s17, s65
    s_add_u32 s40, s40, 0x100000
    s_addc_u32 s41, s41, 0
    s_lshr_b32 s40, s40, 25
    s_or_b32 s40, s40, s41
    s_or_b32 s48, s48, s40
    s_sub_u32 s40, s18, s64
    s_subb_u32 s41, s19, s65
    s_add_u32 s40, s40, 0x100000
    s_addc_u32 s41, s41, 0
    s_lshr_b32 s40, s40, 25
    s_or_b32 s40, s40, s41
    s_or_b32 s48, s48, s40
    s_sub_u32 s40, s24, s64
    s_subb_u32 s41, s25, s65
    s_add_u32 s40, s40, 0x100000
    s_addc_u32 s41, s41, 0
    s_lshr_b32 s40, s40, 25
    s_or_b32 s40, s40, s41
    s_or_b32 s48, s48, s40
    s_sub_u32 s40, s26, s64
    s_subb_u32 s41, s27, s65
    s_add_u32 s40, s40, 0x100000
    s_addc_u32 s41, s41, 0
    s_lshr_b32 s40, s40, 25
    s_or_b32 s40, s40, s41
    s_or_b32 s48, s48, s40
    s_sub_u32 s40, s28, s64
    s_subb_u32 s41, s29, s65
    s_add_u32 s40, s40, 0x100000
    s_addc_u32 s41, s41, 0
    s_lshr_b32 s40, s40, 25
    s_or_b32 s40, s40, s41
    s_or_b32 s48, s48, s40
    s_sub_u32 s40, s30, s64
    s_subb_u32 s41, s31, s65
    s_add_u32 s40, s40, 0x100000
    s_addc_u32 s41, s41, 0
    s_lshr_b32 s40, s40, 25
    s_or_b32 s40, s40, s41
    s_or_b32 s48, s48, s40
    s_cmp_eq_u32 s48, 0
    s_cbranch_scc1 L_s67_go
    s_cmp_gt_u32 s35, 0x40000
    s_cbranch_scc1 L_s67_go
    s_branch L_s67_pl
L_s67_go:
    v_mov_b32 v84, s4
    v_mov_b32 v85, s5
    ds_write_b64 v7, v[84:85] offset:18192
    ds_write_b32 v7, v12 offset:18188
    s_branch L_tile_nocomb
L_tile_comb:
    s_lshl_b32 s51, s3, 10
    v_add_u32 v18, s51, v8
    s_mov_b32 s62, 0
    s_nop 0
L_sp2:
    ds_read_b32 v84, v7 offset:18188
    s_add_u32 s62, s62, 1
    s_waitcnt lgkmcnt(0)
    v_readfirstlane_b32 s60, v84
    s_nop 0
    s_cmp_ge_u32 s60, 1
    s_nop 2
    s_cbranch_scc1 L_sp2_d
    s_cmp_gt_u32 s62, 0x1000000
    s_cbranch_scc1 L_sp2_d
    s_sleep 1
    s_branch L_sp2
L_sp2_d:
    buffer_load_dwordx4 v[76:79], v18, s[36:39], 0 offen offset:0
    s_mov_b32 s51, 6144
    buffer_load_dwordx4 v[80:83], v18, s[36:39], s51 offen
    s_waitcnt vmcnt(0)
    v_lshlrev_b32 v84, 16, v80
    v_and_b32 v85, 0xffff0000, v80
    v_lshlrev_b32 v86, 16, v81
    v_and_b32 v87, 0xffff0000, v81
    v_dot2_f32_bf16 v84, v76, s52, v84
    v_dot2_f32_bf16 v85, v76, s53, v85
    v_dot2_f32_bf16 v86, v77, s52, v86
    v_dot2_f32_bf16 v87, v77, s53, v87
    s_nop 0
    v_cvt_pk_bf16_f32 v76, v84, v85
    s_nop 0
    v_cvt_pk_bf16_f32 v77, v86, v87
    v_lshlrev_b32 v84, 16, v82
    v_and_b32 v85, 0xffff0000, v82
    v_lshlrev_b32 v86, 16, v83
    v_and_b32 v87, 0xffff0000, v83
    v_dot2_f32_bf16 v84, v78, s52, v84
    v_dot2_f32_bf16 v85, v78, s53, v85
    v_dot2_f32_bf16 v86, v79, s52, v86
    v_dot2_f32_bf16 v87, v79, s53, v87
    s_nop 0
    v_cvt_pk_bf16_f32 v78, v84, v85
    s_nop 0
    v_cvt_pk_bf16_f32 v79, v86, v87
    ds_write_b128 v18, v[76:79] offset:0
    v_dot2_f32_bf16 v84, v76, s50, 0
    v_dot2_f32_bf16 v85, v77, s50, 0
    v_dot2_f32_bf16 v84, v78, s50, v84
    v_dot2_f32_bf16 v85, v79, s50, v85
    s_nop 2
    v_add_f32 v84, v84, v85
    v_mov_b32 v85, v84
    s_nop 1
    v_permlane16_swap_b32 v84, v85
    v_add_f32 v84, v84, v85
    v_mov_b32 v85, v84
    s_nop 1
    v_permlane32_swap_b32 v84, v85
    v_add_f32 v84, v84, v85
    v_lshlrev_b32 v85, 3, v10
    s_lshl_b32 s51, s3, 2
    v_add_u32 v85, s51, v85
    ds_write_b32 v85, v84 offset:25856
    s_mov_b64 exec, 1
    ds_add_u32 v7, v12 offset:18176
    s_mov_b64 exec, -1
L_tile_nocomb:
    s_mov_b32 s62, 0
L_wq3:
    ds_read_b128 v[124:127], v7 offset:18176
    s_add_u32 s62, s62, 1
    s_waitcnt lgkmcnt(0)
    v_readfirstlane_b32 s60, v124
    v_readfirstlane_b32 s61, v125
    v_readfirstlane_b32 s63, v126
    s_cmp_ge_u32 s60, 6
    s_nop 3
    s_cbranch_scc1 L_wq3_d
    s_cmp_gt_u32 s62, 0x1000000
    s_cbranch_scc1 L_wq3_d
    s_cmp_lg_u32 s54, 0
    s_cbranch_scc1 L_wq3_s
    s_cmp_ge_u32 s3, 10
    s_cbranch_scc1 L_wq3_s
    s_cmp_eq_u32 s63, 0
    s_cbranch_scc1 L_wq3_s
    s_cmp_lt_u32 s61, 11
    s_cbranch_scc1 L_wq3_s
    s_mul_i32 s50, s89, 6144
    s_add_u32 s50, s50, 131072
    buffer_load_dwordx4 v[44:47], v8, s[36:39], s50 offen offset:0
    buffer_load_dwordx4 v[48:51], v8, s[36:39], s50 offen offset:1024
    buffer_load_dwordx4 v[52:55], v8, s[36:39], s50 offen offset:2048
    buffer_load_dwordx4 v[56:59], v8, s[36:39], s50 offen offset:3072
    s_add_u32 s50, s50, 4096
    buffer_load_dwordx4 v[60:63], v8, s[36:39], s50 offen offset:0
    buffer_load_dwordx4 v[64:67], v8, s[36:39], s50 offen offset:1024
    s_mov_b32 s54, 1
L_wq3_s:
    s_sleep 1
    s_branch L_wq3
L_wq3_d:
    ds_read_b128 v[76:79], v8 offset:0
    ds_read_b128 v[80:83], v8 offset:1024
    ds_read_b128 v[84:87], v8 offset:2048
    ds_read_b128 v[88:91], v8 offset:3072
    ds_read_b128 v[92:95], v8 offset:4096
    ds_read_b128 v[96:99], v8 offset:5120
    v_lshlrev_b32 v18, 3, v10
    ds_read_b128 v[104:107], v18 offset:25856
    ds_read_b64 v[108:109], v18 offset:25872
    s_waitcnt lgkmcnt(7)
    v_mfma_f32_16x16x32_bf16 v[100:103], v[20:23], v[76:79], 0
    s_waitcnt lgkmcnt(6)
    v_mfma_f32_16x16x32_bf16 v[100:103], v[24:27], v[80:83], v[100:103]
    s_waitcnt lgkmcnt(5)
    v_mfma_f32_16x16x32_bf16 v[100:103], v[28:31], v[84:87], v[100:103]
    s_waitcnt lgkmcnt(4)
    v_mfma_f32_16x16x32_bf16 v[100:103], v[32:35], v[88:91], v[100:103]
    s_waitcnt lgkmcnt(3)
    v_mfma_f32_16x16x32_bf16 v[100:103], v[36:39], v[92:95], v[100:103]
    s_waitcnt lgkmcnt(2)
    v_mfma_f32_16x16x32_bf16 v[100:103], v[40:43], v[96:99], v[100:103]
    s_waitcnt lgkmcnt(0)
    v_add_f32 v104, v104, v105
    v_add_f32 v106, v106, v107
    v_add_f32 v108, v108, v109
    v_add_f32 v104, v104, v106
    v_add_f32 v108, v108, v104
    s_nop 5
    s_branch L_tile_logit
L_tile_late:
    s_mov_b32 s62, 0
L_wq4:
    ds_read_b128 v[124:127], v7 offset:18176
    s_add_u32 s62, s62, 1
    s_waitcnt lgkmcnt(0)
    v_readfirstlane_b32 s60, v124
    s_nop 0
    s_cmp_ge_u32 s60, 6
    s_nop 2
    s_cbranch_scc1 L_wq4_d
    s_cmp_gt_u32 s62, 0x1000000
    s_cbranch_scc1 L_wq4_d
    s_sleep 1
    s_branch L_wq4
L_wq4_d:
    ds_read_b128 v[76:79], v8 offset:0
    ds_read_b128 v[80:83], v8 offset:1024
    ds_read_b128 v[84:87], v8 offset:2048
    ds_read_b128 v[88:91], v8 offset:3072
    ds_read_b128 v[92:95], v8 offset:4096
    ds_read_b128 v[96:99], v8 offset:5120
    v_lshlrev_b32 v18, 3, v10
    ds_read_b128 v[104:107], v18 offset:25856
    ds_read_b64 v[108:109], v18 offset:25872
    s_waitcnt lgkmcnt(0)
    v_add_f32 v104, v104, v105
    v_add_f32 v106, v106, v107
    v_add_f32 v108, v108, v109
    v_add_f32 v104, v104, v106
    v_add_f32 v108, v108, v104
    v_mov_b32 v116, 0
    v_mov_b32 v117, 0
    s_waitcnt vmcnt(5)
    ds_read_b128 v[44:47], v14 offset:0
    ds_read_b128 v[48:51], v16 offset:0
    ds_read_b128 v[52:55], v15 offset:0
    ds_read_b128 v[56:59], v17 offset:0
    s_waitcnt lgkmcnt(2)
    v_lshlrev_b32 v60, 16, v48
    v_and_b32 v61, 0xffff0000, v48
    v_lshlrev_b32 v62, 16, v49
    v_and_b32 v63, 0xffff0000, v49
    v_lshlrev_b32 v64, 16, v50
    v_and_b32 v65, 0xffff0000, v50
    v_lshlrev_b32 v66, 16, v51
    v_and_b32 v67, 0xffff0000, v51
    v_dot2_f32_bf16 v60, v44, s52, v60
    v_dot2_f32_bf16 v61, v44, s53, v61
    v_dot2_f32_bf16 v62, v45, s52, v62
    v_dot2_f32_bf16 v63, v45, s53, v63
    v_dot2_f32_bf16 v64, v46, s52, v64
    v_dot2_f32_bf16 v65, v46, s53, v65
    v_dot2_f32_bf16 v66, v47, s52, v66
    v_dot2_f32_bf16 v67, v47, s53, v67
    v_cvt_pk_bf16_f32 v20, v60, v61
    v_cvt_pk_bf16_f32 v21, v62, v63
    v_cvt_pk_bf16_f32 v22, v64, v65
    v_cvt_pk_bf16_f32 v23, v66, v67
    ds_write_b128 v14, v[20:23] offset:0
    s_nop 0
    v_mfma_f32_16x16x32_bf16 v[100:103], v[20:23], v[76:79], 0
    v_mfma_f32_16x16x32_bf16 v[104:107], v[20:23], v[112:115], 0
    v_dot2_f32_bf16 v116, v20, v20, v116
    v_dot2_f32_bf16 v117, v21, v21, v117
    v_dot2_f32_bf16 v116, v22, v22, v116
    v_dot2_f32_bf16 v117, v23, v23, v117
    s_waitcnt lgkmcnt(1)
    v_lshlrev_b32 v60, 16, v56
    v_and_b32 v61, 0xffff0000, v56
    v_lshlrev_b32 v62, 16, v57
    v_and_b32 v63, 0xffff0000, v57
    v_lshlrev_b32 v64, 16, v58
    v_and_b32 v65, 0xffff0000, v58
    v_lshlrev_b32 v66, 16, v59
    v_and_b32 v67, 0xffff0000, v59
    v_dot2_f32_bf16 v60, v52, s52, v60
    v_dot2_f32_bf16 v61, v52, s53, v61
    v_dot2_f32_bf16 v62, v53, s52, v62
    v_dot2_f32_bf16 v63, v53, s53, v63
    v_dot2_f32_bf16 v64, v54, s52, v64
    v_dot2_f32_bf16 v65, v54, s53, v65
    v_dot2_f32_bf16 v66, v55, s52, v66
    v_dot2_f32_bf16 v67, v55, s53, v67
    v_cvt_pk_bf16_f32 v24, v60, v61
    v_cvt_pk_bf16_f32 v25, v62, v63
    v_cvt_pk_bf16_f32 v26, v64, v65
    v_cvt_pk_bf16_f32 v27, v66, v67
    ds_write_b128 v15, v[24:27] offset:0
    s_nop 0
    v_mfma_f32_16x16x32_bf16 v[100:103], v[24:27], v[80:83], v[100:103]
    v_mfma_f32_16x16x32_bf16 v[104:107], v[24:27], v[112:115], v[104:107]
    v_dot2_f32_bf16 v116, v24, v24, v116
    v_dot2_f32_bf16 v117, v25, v25, v117
    v_dot2_f32_bf16 v116, v26, v26, v116
    v_dot2_f32_bf16 v117, v27, v27, v117
    s_waitcnt vmcnt(3)
    ds_read_b128 v[44:47], v14 offset:2048
    ds_read_b128 v[48:51], v16 offset:512
    ds_read_b128 v[52:55], v15 offset:2048
    ds_read_b128 v[56:59], v17 offset:512
    s_waitcnt lgkmcnt(2)
    v_lshlrev_b32 v60, 16, v48
    v_and_b32 v61, 0xffff0000, v48
    v_lshlrev_b32 v62, 16, v49
    v_and_b32 v63, 0xffff0000, v49
    v_lshlrev_b32 v64, 16, v50
    v_and_b32 v65, 0xffff0000, v50
    v_lshlrev_b32 v66, 16, v51
    v_and_b32 v67, 0xffff0000, v51
    v_dot2_f32_bf16 v60, v44, s52, v60
    v_dot2_f32_bf16 v61, v44, s53, v61
    v_dot2_f32_bf16 v62, v45, s52, v62
    v_dot2_f32_bf16 v63, v45, s53, v63
    v_dot2_f32_bf16 v64, v46, s52, v64
    v_dot2_f32_bf16 v65, v46, s53, v65
    v_dot2_f32_bf16 v66, v47, s52, v66
    v_dot2_f32_bf16 v67, v47, s53, v67
    v_cvt_pk_bf16_f32 v28, v60, v61
    v_cvt_pk_bf16_f32 v29, v62, v63
    v_cvt_pk_bf16_f32 v30, v64, v65
    v_cvt_pk_bf16_f32 v31, v66, v67
    ds_write_b128 v14, v[28:31] offset:2048
    s_nop 0
    v_mfma_f32_16x16x32_bf16 v[100:103], v[28:31], v[84:87], v[100:103]
    v_mfma_f32_16x16x32_bf16 v[104:107], v[28:31], v[112:115], v[104:107]
    v_dot2_f32_bf16 v116, v28, v28, v116
    v_dot2_f32_bf16 v117, v29, v29, v117
    v_dot2_f32_bf16 v116, v30, v30, v116
    v_dot2_f32_bf16 v117, v31, v31, v117
    s_waitcnt lgkmcnt(1)
    v_lshlrev_b32 v60, 16, v56
    v_and_b32 v61, 0xffff0000, v56
    v_lshlrev_b32 v62, 16, v57
    v_and_b32 v63, 0xffff0000, v57
    v_lshlrev_b32 v64, 16, v58
    v_and_b32 v65, 0xffff0000, v58
    v_lshlrev_b32 v66, 16, v59
    v_and_b32 v67, 0xffff0000, v59
    v_dot2_f32_bf16 v60, v52, s52, v60
    v_dot2_f32_bf16 v61, v52, s53, v61
    v_dot2_f32_bf16 v62, v53, s52, v62
    v_dot2_f32_bf16 v63, v53, s53, v63
    v_dot2_f32_bf16 v64, v54, s52, v64
    v_dot2_f32_bf16 v65, v54, s53, v65
    v_dot2_f32_bf16 v66, v55, s52, v66
    v_dot2_f32_bf16 v67, v55, s53, v67
    v_cvt_pk_bf16_f32 v32, v60, v61
    v_cvt_pk_bf16_f32 v33, v62, v63
    v_cvt_pk_bf16_f32 v34, v64, v65
    v_cvt_pk_bf16_f32 v35, v66, v67
    ds_write_b128 v15, v[32:35] offset:2048
    s_nop 0
    v_mfma_f32_16x16x32_bf16 v[100:103], v[32:35], v[88:91], v[100:103]
    v_mfma_f32_16x16x32_bf16 v[104:107], v[32:35], v[112:115], v[104:107]
    v_dot2_f32_bf16 v116, v32, v32, v116
    v_dot2_f32_bf16 v117, v33, v33, v117
    v_dot2_f32_bf16 v116, v34, v34, v116
    v_dot2_f32_bf16 v117, v35, v35, v117
    s_waitcnt vmcnt(0)
    ds_read_b128 v[44:47], v14 offset:4096
    ds_read_b128 v[48:51], v16 offset:1024
    ds_read_b128 v[52:55], v15 offset:4096
    ds_read_b128 v[56:59], v17 offset:1024
    s_waitcnt lgkmcnt(2)
    v_lshlrev_b32 v60, 16, v48
    v_and_b32 v61, 0xffff0000, v48
    v_lshlrev_b32 v62, 16, v49
    v_and_b32 v63, 0xffff0000, v49
    v_lshlrev_b32 v64, 16, v50
    v_and_b32 v65, 0xffff0000, v50
    v_lshlrev_b32 v66, 16, v51
    v_and_b32 v67, 0xffff0000, v51
    v_dot2_f32_bf16 v60, v44, s52, v60
    v_dot2_f32_bf16 v61, v44, s53, v61
    v_dot2_f32_bf16 v62, v45, s52, v62
    v_dot2_f32_bf16 v63, v45, s53, v63
    v_dot2_f32_bf16 v64, v46, s52, v64
    v_dot2_f32_bf16 v65, v46, s53, v65
    v_dot2_f32_bf16 v66, v47, s52, v66
    v_dot2_f32_bf16 v67, v47, s53, v67
    v_cvt_pk_bf16_f32 v36, v60, v61
    v_cvt_pk_bf16_f32 v37, v62, v63
    v_cvt_pk_bf16_f32 v38, v64, v65
    v_cvt_pk_bf16_f32 v39, v66, v67
    ds_write_b128 v14, v[36:39] offset:4096
    s_nop 0
    v_mfma_f32_16x16x32_bf16 v[100:103], v[36:39], v[92:95], v[100:103]
    v_mfma_f32_16x16x32_bf16 v[104:107], v[36:39], v[112:115], v[104:107]
    v_dot2_f32_bf16 v116, v36, v36, v116
    v_dot2_f32_bf16 v117, v37, v37, v117
    v_dot2_f32_bf16 v116, v38, v38, v116
    v_dot2_f32_bf16 v117, v39, v39, v117
    s_waitcnt lgkmcnt(1)
    v_lshlrev_b32 v60, 16, v56
    v_and_b32 v61, 0xffff0000, v56
    v_lshlrev_b32 v62, 16, v57
    v_and_b32 v63, 0xffff0000, v57
    v_lshlrev_b32 v64, 16, v58
    v_and_b32 v65, 0xffff0000, v58
    v_lshlrev_b32 v66, 16, v59
    v_and_b32 v67, 0xffff0000, v59
    v_dot2_f32_bf16 v60, v52, s52, v60
    v_dot2_f32_bf16 v61, v52, s53, v61
    v_dot2_f32_bf16 v62, v53, s52, v62
    v_dot2_f32_bf16 v63, v53, s53, v63
    v_dot2_f32_bf16 v64, v54, s52, v64
    v_dot2_f32_bf16 v65, v54, s53, v65
    v_dot2_f32_bf16 v66, v55, s52, v66
    v_dot2_f32_bf16 v67, v55, s53, v67
    v_cvt_pk_bf16_f32 v40, v60, v61
    v_cvt_pk_bf16_f32 v41, v62, v63
    v_cvt_pk_bf16_f32 v42, v64, v65
    v_cvt_pk_bf16_f32 v43, v66, v67
    ds_write_b128 v15, v[40:43] offset:4096
    s_nop 0
    v_mfma_f32_16x16x32_bf16 v[100:103], v[40:43], v[96:99], v[100:103]
    v_mfma_f32_16x16x32_bf16 v[104:107], v[40:43], v[112:115], v[104:107]
    v_dot2_f32_bf16 v116, v40, v40, v116
    v_dot2_f32_bf16 v117, v41, v41, v117
    v_dot2_f32_bf16 v116, v42, v42, v116
    v_dot2_f32_bf16 v117, v43, v43, v117
    s_cmp_eq_u32 s55, 14
    s_nop 6
    s_cbranch_scc1 L_sig1
    s_mov_b64 exec, 1
    ds_add_u32 v7, v12 offset:18200
    s_mov_b64 exec, -1
L_sig1:
    v_add_f32 v116, v116, v117
    s_nop 1
    v_mfma_f32_16x16x4_f32 v[72:75], v116, v9, 0
    v_mul_f32 v68, s49, v104
    v_mul_f32 v69, s49, v105
    v_mul_f32 v70, s49, v106
    v_mul_f32 v71, s49, v107
    s_nop 5
    v_fma_f32 v72, v72, s49, v19
    v_fma_f32 v73, v73, s49, v19
    v_fma_f32 v74, v74, s49, v19
    v_fma_f32 v75, v75, s49, v19
    v_fma_f32 v72, -v68, v68, v72
    v_fma_f32 v73, -v69, v69, v73
    v_fma_f32 v74, -v70, v70, v74
    v_fma_f32 v75, -v71, v71, v75
    v_max_f32 v72, v72, v19
    v_max_f32 v73, v73, v19
    v_max_f32 v74, v74, v19
    v_max_f32 v75, v75, v19
    v_rsq_f32 v72, v72
    v_rsq_f32 v73, v73
    v_rsq_f32 v74, v74
    v_rsq_f32 v75, v75
    s_nop 1
L_tile_logit:
    v_fma_f32 v100, -v68, v108, v100
    v_fma_f32 v101, -v69, v108, v101
    v_fma_f32 v102, -v70, v108, v102
    v_fma_f32 v103, -v71, v108, v103
    v_mul_f32 v100, v100, v72
    v_mul_f32 v101, v101, v73
    v_mul_f32 v102, v102, v74
    v_mul_f32 v103, v103, v75
    s_cmp_ge_u32 s3, s55
    s_nop 0
    s_cbranch_scc1 L_tile_ref
    v_max_f32 v18, v100, v101
    v_max3_f32 v18, v18, v102, v103
    ds_max_f32 v10, v18 offset:15360
    s_mov_b64 exec, 1
    ds_add_u32 v7, v12 offset:18204
    s_mov_b64 exec, -1
L_tile_ref:
    s_mov_b32 s62, 0
L_tile_wm:
    ds_read_b32 v18, v7 offset:18204
    ds_read_b32 v19, v10 offset:15360
    s_add_u32 s62, s62, 1
    s_waitcnt lgkmcnt(0)
    v_readfirstlane_b32 s60, v18
    s_nop 0
    s_cmp_ge_u32 s60, s55
    s_nop 2
    s_cbranch_scc1 L_tile_wm_d
    s_cmp_gt_u32 s62, 0x1000000
    s_cbranch_scc1 L_tile_wm_d
    s_branch L_tile_wm
L_tile_wm_d:
    v_sub_f32 v100, v100, v19
    v_sub_f32 v101, v101, v19
    v_sub_f32 v102, v102, v19
    v_sub_f32 v103, v103, v19
    v_exp_f32 v104, v100
    v_exp_f32 v105, v101
    v_exp_f32 v106, v102
    v_exp_f32 v107, v103
    v_max_f32 v18, v100, v101
    v_max3_f32 v18, v18, v102, v103
    v_cmp_lt_f32 vcc, 0x42800000, v18
    v_mul_f32 v100, v104, v72
    v_mul_f32 v101, v105, v73
    v_mul_f32 v102, v106, v74
    v_mul_f32 v103, v107, v75
    v_cvt_pk_bf16_f32 v116, v100, v101
    v_cvt_pk_bf16_f32 v117, v102, v103
    ds_write_b64 v4, v[116:117] offset:6144
    v_lshlrev_b32 v100, 16, v116
    v_and_b32 v101, 0xffff0000, v116
    v_lshlrev_b32 v102, 16, v117
    v_and_b32 v103, 0xffff0000, v117
    s_cmp_eq_u64 vcc, 0
    s_nop 0
    s_cbranch_scc1 L_tile_noovf
    ds_write_b32 v7, v12 offset:18212
L_tile_noovf:
    s_mov_b64 exec, 1
    ds_or_b32 v7, v13 offset:18208
    s_mov_b64 exec, -1
    v_add_f32 v118, v104, v105
    v_add_f32 v119, v106, v107
    v_mul_f32 v120, v100, v68
    v_add_f32 v118, v118, v119
    v_fmac_f32 v120, v101, v69
    v_fmac_f32 v120, v102, v70
    v_fmac_f32 v120, v103, v71
    v_mov_b32 v119, v118
    v_mov_b32 v121, v120
    s_nop 0
    v_permlane16_swap_b32 v118, v119
    v_permlane16_swap_b32 v120, v121
    v_add_f32 v118, v118, v119
    v_add_f32 v120, v120, v121
    v_mov_b32 v119, v118
    v_mov_b32 v121, v120
    s_nop 0
    v_permlane32_swap_b32 v118, v119
    v_permlane32_swap_b32 v120, v121
    v_add_f32 v118, v118, v119
    v_add_f32 v120, v120, v121
    ds_write_b32 v6, v118 offset:15616
    ds_write_b32 v6, v120 offset:16896
    s_mov_b64 exec, 1
    ds_or_b32 v7, v13 offset:18216
    s_mov_b64 exec, -1
    s_setprio 0
    s_cmp_ge_u32 s3, 10
    s_cbranch_scc1 L_s_fin
L_pv:
    v_add_u32 v15, 49152, v5
    s_mov_b32 s62, 0
    s_nop 0
L_sp5:
    ds_read_b32 v18, v7 offset:18208
    s_add_u32 s62, s62, 1
    s_waitcnt lgkmcnt(0)
    v_readfirstlane_b32 s60, v18
    s_nop 0
    s_and_b32 s63, s60, 255
    s_cmp_eq_u32 s63, 255
    s_nop 1
    s_cbranch_scc1 L_sp5_d
    s_cmp_gt_u32 s62, 0x1000000
    s_cbranch_scc1 L_sp5_d
    s_sleep 1
    s_branch L_sp5
L_sp5_d:
    s_and_b32 s61, s60, 0xf00
    s_cmp_eq_u32 s61, 0xf00
    s_cbranch_scc1 L_pv_all
    ds_read_b128 v[72:75], v8 offset:6144
    ds_read_b64_tr_b16 v[20:21], v5 offset:0
    ds_read_b64_tr_b16 v[22:23], v5 offset:6144
    ds_read_b128 v[76:79], v8 offset:7168
    ds_read_b64_tr_b16 v[24:25], v5 offset:12288
    ds_read_b64_tr_b16 v[26:27], v5 offset:18432
    ds_read_b128 v[80:83], v8 offset:8192
    ds_read_b64_tr_b16 v[28:29], v5 offset:24576
    ds_read_b64_tr_b16 v[30:31], v5 offset:30720
    ds_read_b128 v[84:87], v8 offset:9216
    ds_read_b64_tr_b16 v[32:33], v5 offset:36864
    ds_read_b64_tr_b16 v[34:35], v5 offset:43008
    s_waitcnt lgkmcnt(9)
    v_mfma_f32_16x16x32_bf16 v[124:127], v[20:23], v[72:75], 0
    s_waitcnt lgkmcnt(6)
    v_mfma_f32_16x16x32_bf16 v[124:127], v[24:27], v[76:79], v[124:127]
    s_waitcnt lgkmcnt(3)
    v_mfma_f32_16x16x32_bf16 v[124:127], v[28:31], v[80:83], v[124:127]
    s_waitcnt lgkmcnt(0)
    v_mfma_f32_16x16x32_bf16 v[124:127], v[32:35], v[84:87], v[124:127]
    s_mov_b32 s62, 0
    s_nop 10
L_sp6:
    ds_read_b32 v18, v7 offset:18208
    s_add_u32 s62, s62, 1
    s_waitcnt lgkmcnt(0)
    v_readfirstlane_b32 s60, v18
    s_nop 0
    s_and_b32 s63, s60, 3840
    s_cmp_eq_u32 s63, 3840
    s_nop 1
    s_cbranch_scc1 L_sp6_d
    s_cmp_gt_u32 s62, 0x1000000
    s_cbranch_scc1 L_sp6_d
    s_branch L_sp6
L_sp6_d:
    ds_read_b128 v[88:91], v8 offset:10240
    ds_read_b64_tr_b16 v[36:37], v15 offset:0
    ds_read_b64_tr_b16 v[38:39], v15 offset:6144
    ds_read_b128 v[92:95], v8 offset:11264
    ds_read_b64_tr_b16 v[40:41], v15 offset:12288
    ds_read_b64_tr_b16 v[42:43], v15 offset:18432
    s_waitcnt lgkmcnt(3)
    v_mfma_f32_16x16x32_bf16 v[124:127], v[36:39], v[88:91], v[124:127]
    s_waitcnt lgkmcnt(0)
    v_mfma_f32_16x16x32_bf16 v[124:127], v[40:43], v[92:95], v[124:127]
    s_nop 11
    s_branch L_pv_done
L_pv_all:
    ds_read_b128 v[72:75], v8 offset:6144
    ds_read_b64_tr_b16 v[20:21], v5 offset:0
    ds_read_b64_tr_b16 v[22:23], v5 offset:6144
    ds_read_b128 v[76:79], v8 offset:7168
    ds_read_b64_tr_b16 v[24:25], v5 offset:12288
    ds_read_b64_tr_b16 v[26:27], v5 offset:18432
    ds_read_b128 v[80:83], v8 offset:8192
    ds_read_b64_tr_b16 v[28:29], v5 offset:24576
    ds_read_b64_tr_b16 v[30:31], v5 offset:30720
    ds_read_b128 v[84:87], v8 offset:9216
    ds_read_b64_tr_b16 v[32:33], v5 offset:36864
    ds_read_b64_tr_b16 v[34:35], v5 offset:43008
    s_waitcnt lgkmcnt(9)
    v_mfma_f32_16x16x32_bf16 v[124:127], v[20:23], v[72:75], 0
    ds_read_b128 v[88:91], v8 offset:10240
    ds_read_b64_tr_b16 v[36:37], v15 offset:0
    ds_read_b64_tr_b16 v[38:39], v15 offset:6144
    ds_read_b128 v[92:95], v8 offset:11264
    ds_read_b64_tr_b16 v[40:41], v15 offset:12288
    ds_read_b64_tr_b16 v[42:43], v15 offset:18432
    s_waitcnt lgkmcnt(12)
    v_mfma_f32_16x16x32_bf16 v[124:127], v[24:27], v[76:79], v[124:127]
    s_waitcnt lgkmcnt(9)
    v_mfma_f32_16x16x32_bf16 v[124:127], v[28:31], v[80:83], v[124:127]
    s_waitcnt lgkmcnt(6)
    v_mfma_f32_16x16x32_bf16 v[124:127], v[32:35], v[84:87], v[124:127]
    s_waitcnt lgkmcnt(3)
    v_mfma_f32_16x16x32_bf16 v[124:127], v[36:39], v[88:91], v[124:127]
    s_waitcnt lgkmcnt(0)
    v_mfma_f32_16x16x32_bf16 v[124:127], v[40:43], v[92:95], v[124:127]
    s_nop 11
L_pv_done:
    s_cmp_lg_u32 s54, 0
    s_cbranch_scc1 L_pv_havew
    s_mov_b32 s62, 0
L_sp7:
    ds_read_b32 v18, v7 offset:18184
    s_add_u32 s62, s62, 1
    s_waitcnt lgkmcnt(0)
    v_readfirstlane_b32 s60, v18
    s_nop 0
    s_cmp_ge_u32 s60, 1
    s_nop 2
    s_cbranch_scc1 L_sp7_d
    s_cmp_gt_u32 s62, 0x1000000
    s_cbranch_scc1 L_sp7_d
    s_sleep 1
    s_branch L_sp7
L_sp7_d:
    s_mul_i32 s50, s89, 6144
    s_add_u32 s50, s50, 131072
    buffer_load_dwordx4 v[44:47], v8, s[36:39], s50 offen offset:0
    buffer_load_dwordx4 v[48:51], v8, s[36:39], s50 offen offset:1024
    buffer_load_dwordx4 v[52:55], v8, s[36:39], s50 offen offset:2048
    buffer_load_dwordx4 v[56:59], v8, s[36:39], s50 offen offset:3072
    s_add_u32 s50, s50, 4096
    buffer_load_dwordx4 v[60:63], v8, s[36:39], s50 offen offset:0
    buffer_load_dwordx4 v[64:67], v8, s[36:39], s50 offen offset:1024
    s_mov_b32 s54, 1
L_pv_havew:
    v_lshrrev_b32 v20, 5, v1
    v_lshlrev_b32 v16, 8, v20
    v_and_b32 v20, 15, v1
    v_lshl_add_u32 v16, v20, 4, v16
    v_bfe_u32 v20, v1, 4, 1
    v_lshl_add_u32 v16, v20, 3, v16
    s_lshl_b32 s73, s89, 9
    s_add_u32 s73, s73, 18432
    v_add_u32 v16, s73, v16
    v_lshlrev_b32 v17, 2, v2
    v_add_u32 v17, v17, v3
    v_lshlrev_b32 v17, 4, v17
    v_lshlrev_b32 v18, 1, v10
    s_mul_i32 s50, s89, 224
    s_add_u32 s50, s50, s33
    s_lshl_b32 s50, s50, 10
    s_cmp_eq_u32 s3, 14
    s_cbranch_scc0 L_pv_noclaim
    s_cmp_eq_u32 s55, 14
    s_cbranch_scc1 L_pv_noclaim
    s_mov_b32 s40, s20
    s_mov_b32 s41, s21
    s_mov_b32 s42, 256
    s_mov_b32 s43, 0x20000
    s_and_b32 s44, s33, 7
    s_lshl_b32 s45, s44, 5
    v_mov_b32 v120, s45
    v_mov_b32 v121, 1
    s_mov_b64 exec, 1
    buffer_atomic_add v121, v120, s[40:43], 0 offen sc0
    s_mov_b64 exec, -1
    s_nop 0
L_pv_noclaim:
    s_setprio 3
    s_barrier
    ds_read_b128 v[76:79], v8 offset:12288
    ds_read_b64_tr_b16 v[28:29], v15 offset:24576
    ds_read_b64_tr_b16 v[30:31], v15 offset:30720
    ds_read_b64 v[40:41], v11 offset:16944
    ds_read_b64 v[42:43], v11 offset:15664
    ds_read_b64 v[38:39], v18 offset:26368
    ds_read_b32 v18, v7 offset:18212
    ds_read_b32 v22, v7 offset:18192
    ds_read_b32 v122, v10 offset:15360
    s_waitcnt lgkmcnt(6)
    v_mfma_f32_16x16x32_bf16 v[124:127], v[28:31], v[76:79], v[124:127]
    v_cmp_ne_u32 vcc, 3, v3
    s_waitcnt lgkmcnt(3)
    v_add_f32 v38, v38, v40
    v_add_f32 v39, v39, v42
    v_add_f32 v38, v38, v41
    v_add_f32 v39, v39, v43
    s_nop 1
    v_sub_f32 v124, v124, v38
    v_sub_f32 v125, v125, v38
    v_sub_f32 v126, v126, v38
    v_sub_f32 v127, v127, v38
    v_cvt_pk_bf16_f32 v20, v124, v125
    v_cvt_pk_bf16_f32 v21, v126, v127
    ds_write_b64 v16, v[20:21]
    s_waitcnt lgkmcnt(0)
    v_cndmask_b32 v23, v39, v122, vcc
    v_readfirstlane_b32 s53, v18
    s_nop 4
    s_branch L_s_f1
L_s_fin:
    s_mov_b32 s89, 255
    s_cmp_eq_u32 s3, 11
    s_cbranch_scc0 L_s_fin2
    s_mov_b32 s62, 0
L_sp8:
    ds_read_b32 v18, v7 offset:18216
    s_add_u32 s62, s62, 1
    s_waitcnt lgkmcnt(0)
    v_readfirstlane_b32 s60, v18
    s_nop 0
    s_and_b32 s63, s60, 4095
    s_cmp_eq_u32 s63, 4095
    s_nop 1
    s_cbranch_scc1 L_sp8_d
    s_cmp_gt_u32 s62, 0x1000000
    s_cbranch_scc1 L_sp8_d
    s_branch L_sp8
L_sp8_d:
    ds_read_b128 v[40:43], v11 offset:16896
    ds_read_b128 v[76:79], v11 offset:15616
    ds_read_b128 v[44:47], v11 offset:16912
    ds_read_b128 v[80:83], v11 offset:15632
    ds_read_b128 v[48:51], v11 offset:16928
    ds_read_b128 v[84:87], v11 offset:15648
    s_waitcnt lgkmcnt(0)
    v_add_f32 v40, v40, v41
    v_add_f32 v42, v42, v43
    v_add_f32 v44, v44, v45
    v_add_f32 v46, v46, v47
    v_add_f32 v48, v48, v49
    v_add_f32 v50, v50, v51
    v_add_f32 v40, v40, v42
    v_add_f32 v44, v44, v46
    v_add_f32 v48, v48, v50
    v_add_f32 v40, v40, v44
    v_add_f32 v24, v40, v48
    v_add_f32 v76, v76, v77
    v_add_f32 v78, v78, v79
    v_add_f32 v80, v80, v81
    v_add_f32 v82, v82, v83
    v_add_f32 v84, v84, v85
    v_add_f32 v86, v86, v87
    v_add_f32 v76, v76, v78
    v_add_f32 v80, v80, v82
    v_add_f32 v84, v84, v86
    v_add_f32 v76, v76, v80
    v_add_f32 v25, v76, v84
    v_lshlrev_b32 v26, 1, v10
    ds_write_b64 v26, v[24:25] offset:26368
    s_nop 0
L_s_fin2:
    s_waitcnt lgkmcnt(0)
    s_barrier
    ds_read_b32 v18, v7 offset:18212
    ds_read_b32 v22, v7 offset:18192
    s_waitcnt lgkmcnt(0)
    v_readfirstlane_b32 s53, v18
    s_nop 4
L_s_f1:
    s_barrier
    s_cmp_lg_u32 s53, 0
    s_cbranch_scc1 L_s_redo
    s_cmp_ge_u32 s89, 12
    s_cbranch_scc1 L_s_red
    ds_read_b128 v[76:79], v8 offset:18432
    ds_read_b128 v[80:83], v8 offset:19456
    ds_read_b128 v[84:87], v8 offset:20480
    ds_read_b128 v[88:91], v8 offset:21504
    ds_read_b128 v[92:95], v8 offset:22528
    ds_read_b128 v[96:99], v8 offset:23552
    s_waitcnt vmcnt(1)
    s_cmp_eq_u32 s3, 14
    s_cbranch_scc1 L_gm_go
    s_waitcnt vmcnt(0)
L_gm_go:
    s_waitcnt lgkmcnt(5)
    v_mfma_f32_16x16x32_bf16 v[124:127], v[44:47], v[76:79], 0
    s_waitcnt lgkmcnt(4)
    v_mfma_f32_16x16x32_bf16 v[124:127], v[48:51], v[80:83], v[124:127]
    s_waitcnt lgkmcnt(3)
    v_mfma_f32_16x16x32_bf16 v[124:127], v[52:55], v[84:87], v[124:127]
    s_waitcnt lgkmcnt(2)
    v_mfma_f32_16x16x32_bf16 v[124:127], v[56:59], v[88:91], v[124:127]
    s_waitcnt lgkmcnt(1)
    v_mfma_f32_16x16x32_bf16 v[124:127], v[60:63], v[92:95], v[124:127]
    s_waitcnt lgkmcnt(0)
    v_mfma_f32_16x16x32_bf16 v[124:127], v[64:67], v[96:99], v[124:127]
    s_nop 7
    v_cvt_pk_bf16_f32 v20, v124, v125
    v_cvt_pk_bf16_f32 v21, v126, v127
    buffer_store_dwordx4 v[20:23], v17, s[96:99], s50 offen sc0 sc1
    s_nop 1
L_s_red:
    s_cmp_eq_u32 s3, 14
    s_cbranch_scc0 L_s_nosl
    s_waitcnt vmcnt(1)
    s_and_b32 s44, s33, 7
    s_mul_i32 s44, s44, 24
    v_add_u32 v26, s44, v121
    v_add_u32 v26, 1, v26
    v_cmp_gt_u32 vcc, 24, v121
    s_nop 1
    v_cndmask_b32 v26, 0, v26, vcc
    s_mov_b64 exec, 1
    ds_write_b32 v7, v26 offset:18220
    s_mov_b64 exec, -1
    s_waitcnt lgkmcnt(0)
L_s_nosl:
    s_barrier
    s_cmp_ge_u32 s3, 14
    s_cbranch_scc1 L_s_end
    ds_read_b32 v18, v7 offset:18220
    s_waitcnt lgkmcnt(0)
    v_readfirstlane_b32 s33, v18
    s_nop 0
    s_cmp_eq_u32 s33, 0
    s_nop 2
    s_cbranch_scc1 L_s_end
    s_sub_u32 s33, s33, 1
    s_min_u32 s33, s33, 191
    s_mul_i32 s50, s33, 171
    s_lshr_b32 s50, s50, 11
    s_mul_i32 s51, s50, 12
    s_sub_u32 s51, s33, s51
    s_lshl_b32 s50, s50, 6
    s_mul_i32 s51, s51, 224
    s_lshl_b32 s52, s3, 4
    s_add_u32 s51, s51, s52
    s_lshl_b32 s51, s51, 10
    s_add_u32 s50, s50, s51
    v_and_b32 v8, 15, v1
    v_lshlrev_b32 v8, 10, v8
    v_lshrrev_b32 v9, 4, v1
    v_lshl_add_u32 v8, v9, 4, v8
    v_lshlrev_b32 v31, 6, v1
    v_and_b32 v31, 0x3c0, v31
    v_lshl_add_u32 v31, v9, 4, v31
    s_cmp_lg_u32 s3, 0
    s_nop 0
    s_cbranch_scc1 L_s_noq
    s_mov_b32 s36, s82
    s_mov_b32 s37, s83
    s_mov_b32 s38, 6144
    s_mov_b32 s39, 0x20000
    v_lshlrev_b32 v30, 3, v9
    s_lshl_b32 s52, s33, 5
    buffer_load_dwordx2 v[32:33], v30, s[36:39], s52 offen
L_s_noq:
    s_mov_b32 s62, 0
    s_sleep 8
    s_sleep 8
    s_sleep 8
L_s_rp0:
    buffer_load_dwordx4 v[24:27], v8, s[96:99], s50 offen sc0 sc1
    s_add_u32 s62, s62, 1
    s_waitcnt vmcnt(0)
    s_mov_b64 exec, -1
    v_cmp_ne_u32 vcc, v26, v22
    s_nop 0
    s_cmp_eq_u64 vcc, 0
    s_nop 2
    s_cbranch_scc1 L_s_rp_d
    s_cmp_gt_u32 s62, 0x40000
    s_cbranch_scc1 L_s_rp_d
    s_mov_b64 exec, vcc
    s_bcnt1_i32_b64 s61, vcc
    s_cmp_le_u32 s61, 16
    s_cbranch_scc1 L_s_rpf
    s_sleep 4
    s_branch L_s_rp0
L_s_rpf:
    buffer_load_dwordx4 v[24:27], v8, s[96:99], s50 offen sc0 sc1
    s_sleep 4
    buffer_load_dwordx4 v[24:27], v8, s[96:99], s50 offen sc0 sc1
    s_sleep 4
L_s_rp:
    buffer_load_dwordx4 v[24:27], v8, s[96:99], s50 offen sc0 sc1
    s_add_u32 s62, s62, 1
    s_waitcnt vmcnt(2)
    s_mov_b64 exec, -1
    v_cmp_ne_u32 vcc, v26, v22
    s_nop 0
    s_cmp_eq_u64 vcc, 0
    s_nop 2
    s_cbranch_scc1 L_s_rp_d
    s_cmp_gt_u32 s62, 0x40000
    s_cbranch_scc1 L_s_rp_d
    s_mov_b64 exec, vcc
    s_sleep 3
    s_branch L_s_rp
L_s_rp_d:
    s_mov_b64 exec, -1
    v_mov_b32 v28, v27
    v_mov_b32 v29, v27
    v_lshlrev_b32 v36, 16, v24
    v_and_b32 v37, 0xffff0000, v24
    v_permlane16_swap_b32 v28, v29
    v_lshlrev_b32 v38, 16, v25
    v_and_b32 v39, 0xffff0000, v25
    v_mov_b32 v34, v28
    s_nop 1
    v_max_f32_dpp v34, v34, v34 quad_perm:[1,0,3,2] row_mask:0xf bank_mask:0xf
    s_nop 1
    v_max_f32_dpp v34, v34, v34 quad_perm:[2,3,0,1] row_mask:0xf bank_mask:0xf
    s_nop 1
    v_max_f32_dpp v34, v34, v34 row_half_mirror row_mask:0xf bank_mask:0xf
    s_nop 1
    v_max_f32_dpp v34, v34, v34 row_mirror row_mask:0xf bank_mask:0xf
    v_sub_f32 v40, v28, v34
    v_exp_f32 v40, v40
    s_nop 0
    v_mul_f32 v36, v36, v40
    v_mul_f32 v37, v37, v40
    v_mul_f32 v38, v38, v40
    v_mul_f32 v39, v39, v40
    v_mul_f32 v35, v40, v29
    v_add_f32_dpp v36, v36, v36 quad_perm:[1,0,3,2] row_mask:0xf bank_mask:0xf
    v_add_f32_dpp v37, v37, v37 quad_perm:[1,0,3,2] row_mask:0xf bank_mask:0xf
    v_add_f32_dpp v38, v38, v38 quad_perm:[1,0,3,2] row_mask:0xf bank_mask:0xf
    v_add_f32_dpp v39, v39, v39 quad_perm:[1,0,3,2] row_mask:0xf bank_mask:0xf
    v_add_f32_dpp v35, v35, v35 quad_perm:[1,0,3,2] row_mask:0xf bank_mask:0xf
    v_add_f32_dpp v36, v36, v36 quad_perm:[2,3,0,1] row_mask:0xf bank_mask:0xf
    v_add_f32_dpp v37, v37, v37 quad_perm:[2,3,0,1] row_mask:0xf bank_mask:0xf
    v_add_f32_dpp v38, v38, v38 quad_perm:[2,3,0,1] row_mask:0xf bank_mask:0xf
    v_add_f32_dpp v39, v39, v39 quad_perm:[2,3,0,1] row_mask:0xf bank_mask:0xf
    v_add_f32_dpp v35, v35, v35 quad_perm:[2,3,0,1] row_mask:0xf bank_mask:0xf
    v_add_f32_dpp v36, v36, v36 row_half_mirror row_mask:0xf bank_mask:0xf
    v_add_f32_dpp v37, v37, v37 row_half_mirror row_mask:0xf bank_mask:0xf
    v_add_f32_dpp v38, v38, v38 row_half_mirror row_mask:0xf bank_mask:0xf
    v_add_f32_dpp v39, v39, v39 row_half_mirror row_mask:0xf bank_mask:0xf
    v_add_f32_dpp v35, v35, v35 row_half_mirror row_mask:0xf bank_mask:0xf
    v_add_f32_dpp v36, v36, v36 row_mirror row_mask:0xf bank_mask:0xf
    v_add_f32_dpp v37, v37, v37 row_mirror row_mask:0xf bank_mask:0xf
    v_add_f32_dpp v38, v38, v38 row_mirror row_mask:0xf bank_mask:0xf
    v_add_f32_dpp v39, v39, v39 row_mirror row_mask:0xf bank_mask:0xf
    v_add_f32_dpp v35, v35, v35 row_mirror row_mask:0xf bank_mask:0xf
    s_lshl_b32 s51, s3, 6
    v_lshl_add_u32 v41, v9, 4, s51
    s_lshl_b32 s51, s3, 3
    v_mov_b32 v42, s51
    s_mov_b32 exec_lo, 0x00010001
    s_mov_b32 exec_hi, 0x00010001
    ds_write_b128 v41, v[36:39] offset:24576
    s_mov_b32 exec_lo, 0
    s_mov_b32 exec_hi, 1
    ds_write_b64 v42, v[34:35] offset:25600
    s_mov_b64 exec, -1
    s_waitcnt lgkmcnt(0)
    s_barrier
    s_cmp_eq_u32 s3, 0
    s_cbranch_scc1 L_s_fin0
    s_cmp_lg_u32 s3, 2
    s_cbranch_scc1 L_s_end
    s_cmp_ge_u32 s33, 128
    s_cbranch_scc1 L_s_end
    s_mov_b32 s36, s22
    s_mov_b32 s37, s23
    s_mov_b32 s38, 1048576
    s_mov_b32 s39, 0x20000
    v_mov_b32 v36, 0
    v_mov_b32 v37, 0
    v_mov_b32 v38, 0
    v_mov_b32 v39, 0
    s_lshl_b32 s52, s33, 8
    s_add_u32 s52, s52, 65536
    v_lshlrev_b32 v8, 4, v1
    s_mov_b64 exec, 0xfff
    buffer_store_dwordx4 v[36:39], v8, s[36:39], s52 offen sc0 sc1
    s_endpgm
    s_nop 0
L_s_fin0:
    v_mov_b32 v28, 0xff800000
    v_mov_b32 v29, 0
    v_mov_b32 v36, 0
    v_mov_b32 v37, 0
    v_mov_b32 v38, 0
    v_mov_b32 v39, 0
    v_and_b32 v41, 15, v1
    v_lshlrev_b32 v42, 3, v41
    s_mov_b32 exec_lo, 0x3fff3fff
    s_mov_b32 exec_hi, 0x3fff3fff
    ds_read_b128 v[36:39], v31 offset:24576
    ds_read_b64 v[28:29], v42 offset:25600
    s_mov_b64 exec, -1
    s_waitcnt lgkmcnt(0)
    v_mov_b32 v34, v28
    s_nop 1
    v_max_f32_dpp v34, v34, v34 quad_perm:[1,0,3,2] row_mask:0xf bank_mask:0xf
    s_nop 1
    v_max_f32_dpp v34, v34, v34 quad_perm:[2,3,0,1] row_mask:0xf bank_mask:0xf
    s_nop 1
    v_max_f32_dpp v34, v34, v34 row_half_mirror row_mask:0xf bank_mask:0xf
    s_nop 1
    v_max_f32_dpp v34, v34, v34 row_mirror row_mask:0xf bank_mask:0xf
    v_sub_f32 v40, v28, v34
    v_exp_f32 v40, v40
    s_nop 0
    v_mul_f32 v36, v36, v40
    v_mul_f32 v37, v37, v40
    v_mul_f32 v38, v38, v40
    v_mul_f32 v39, v39, v40
    v_mul_f32 v35, v40, v29
    v_add_f32_dpp v36, v36, v36 quad_perm:[1,0,3,2] row_mask:0xf bank_mask:0xf
    v_add_f32_dpp v37, v37, v37 quad_perm:[1,0,3,2] row_mask:0xf bank_mask:0xf
    v_add_f32_dpp v38, v38, v38 quad_perm:[1,0,3,2] row_mask:0xf bank_mask:0xf
    v_add_f32_dpp v39, v39, v39 quad_perm:[1,0,3,2] row_mask:0xf bank_mask:0xf
    v_add_f32_dpp v35, v35, v35 quad_perm:[1,0,3,2] row_mask:0xf bank_mask:0xf
    v_add_f32_dpp v36, v36, v36 quad_perm:[2,3,0,1] row_mask:0xf bank_mask:0xf
    v_add_f32_dpp v37, v37, v37 quad_perm:[2,3,0,1] row_mask:0xf bank_mask:0xf
    v_add_f32_dpp v38, v38, v38 quad_perm:[2,3,0,1] row_mask:0xf bank_mask:0xf
    v_add_f32_dpp v39, v39, v39 quad_perm:[2,3,0,1] row_mask:0xf bank_mask:0xf
    v_add_f32_dpp v35, v35, v35 quad_perm:[2,3,0,1] row_mask:0xf bank_mask:0xf
    v_add_f32_dpp v36, v36, v36 row_half_mirror row_mask:0xf bank_mask:0xf
    v_add_f32_dpp v37, v37, v37 row_half_mirror row_mask:0xf bank_mask:0xf
    v_add_f32_dpp v38, v38, v38 row_half_mirror row_mask:0xf bank_mask:0xf
    v_add_f32_dpp v39, v39, v39 row_half_mirror row_mask:0xf bank_mask:0xf
    v_add_f32_dpp v35, v35, v35 row_half_mirror row_mask:0xf bank_mask:0xf
    v_add_f32_dpp v36, v36, v36 row_mirror row_mask:0xf bank_mask:0xf
    v_add_f32_dpp v37, v37, v37 row_mirror row_mask:0xf bank_mask:0xf
    v_add_f32_dpp v38, v38, v38 row_mirror row_mask:0xf bank_mask:0xf
    v_add_f32_dpp v39, v39, v39 row_mirror row_mask:0xf bank_mask:0xf
    v_add_f32_dpp v35, v35, v35 row_mirror row_mask:0xf bank_mask:0xf
    v_rcp_f32 v35, v35
    v_lshlrev_b32 v44, 16, v32
    v_and_b32 v45, 0xffff0000, v32
    v_lshlrev_b32 v46, 16, v33
    v_and_b32 v47, 0xffff0000, v33
    v_fma_f32 v36, v36, v35, v44
    v_fma_f32 v37, v37, v35, v45
    v_fma_f32 v38, v38, v35, v46
    v_fma_f32 v39, v39, v35, v47
    v_cvt_pk_bf16_f32 v36, v36, v37
    v_cvt_pk_bf16_f32 v37, v38, v39
    s_mov_b32 s36, s100
    s_mov_b32 s37, s101
    s_mov_b32 s38, 6144
    s_mov_b32 s39, 0x20000
    s_mov_b32 exec_lo, 0x00010001
    s_mov_b32 exec_hi, 0x00010001
    buffer_store_dwordx2 v[36:37], v30, s[36:39], s52 offen
    s_mov_b64 exec, -1
    s_endpgm
L_s_end:
    s_endpgm
L_s_redo:
    s_barrier
    s_cmp_eq_u32 s3, 15
    s_cbranch_scc0 L_s_redo2
    v_mov_b32 v24, 0
    v_mov_b32 v25, 0
    ds_write_b32 v7, v24 offset:18204
    ds_write_b64 v7, v[24:25] offset:18208
    ds_write_b32 v7, v24 offset:18216
    v_mov_b32 v24, 0xff800000
    ds_write_b32 v10, v24 offset:15360
    s_waitcnt lgkmcnt(0)
L_s_redo2:
    s_barrier
    s_mov_b32 s55, 14
    s_setprio 0
    s_cmp_ge_u32 s3, 14
    s_cbranch_scc1 L_pv
    s_mov_b32 s89, s3
    v_lshlrev_b32 v20, 7, v2
    v_add_u32 v20, s44, v20
    v_and_b32 v21, 2, v2
    v_xor_b32 v21, v21, v3
    v_lshl_add_u32 v20, v21, 4, v20
    v_and_b32 v21, 4, v2
    v_lshlrev_b32 v21, 4, v21
    v_add_u32 v14, v20, v21
    v_xor_b32 v21, 64, v21
    v_add_u32 v15, v20, v21
    v_lshrrev_b32 v20, 2, v2
    v_lshlrev_b32 v20, 7, v20
    v_add_u32 v20, s45, v20
    s_and_b32 s47, s46, 2
    s_and_b32 s48, s46, 4
    s_lshl_b32 s48, s48, 4
    v_xor_b32 v21, s47, v3
    v_lshl_add_u32 v20, v21, 4, v20
    v_mov_b32 v16, 13312
    v_mov_b32 v17, 13312
    s_mov_b32 s50, 0x3f803f80
    s_nop 0
    s_branch L_tile
L_s_helper:
    v_lshlrev_b32 v8, 4, v1
    v_mov_b32 v7, 0
    v_and_b32 v2, 15, v1
    v_lshrrev_b32 v3, 4, v1
    v_mul_u32_u24 v11, 80, v2
    v_lshlrev_b32 v10, 2, v2
    v_mov_b32 v12, 1
    v_mov_b32 v20, 0
    v_mov_b32 v21, 0
    v_mov_b32 v22, 0
    v_mov_b32 v23, 0
    s_sub_u32 s89, s3, 4
    s_mov_b32 s54, 0
    v_bfe_u32 v100, v1, 2, 4
    v_lshlrev_b32 v101, 7, v100
    v_and_b32 v102, 6, v100
    v_bfe_u32 v103, v1, 1, 1
    s_and_b32 s51, s89, 3
    s_lshl_b32 s51, s51, 1
    v_add_u32 v103, s51, v103
    v_xor_b32 v102, v102, v103
    v_lshl_add_u32 v101, v102, 4, v101
    v_and_b32 v102, 1, v1
    v_lshl_add_u32 v5, v102, 3, v101
    s_lshr_b32 s51, s89, 2
    s_lshl_b32 s51, s51, 11
    s_add_u32 s51, s51, 48128
    v_add_u32 v5, s51, v5
    s_cmp_eq_u32 s3, 15
    s_nop 0
    s_cbranch_scc1 L_s_h15
    ds_write_b128 v8, v[20:23] offset:13312
    ds_write_b128 v8, v[20:23] offset:14336
    s_waitcnt lgkmcnt(0)
    s_branch L_s_hb0
L_s_h15:
    ds_write_b128 v7, v[20:23] offset:18176
    ds_write_b128 v7, v[20:23] offset:18192
    ds_write_b128 v7, v[20:23] offset:18208
    v_mov_b32 v24, 0xff800000
    ds_write_b32 v10, v24 offset:15360
    s_waitcnt lgkmcnt(0)
L_s_hb0:
    s_barrier
    s_mov_b32 s36, s22
    s_mov_b32 s37, s23
    s_mov_b32 s38, 1048576
    s_mov_b32 s39, 0x20000
    s_add_u32 s96, s22, 1048576
    s_addc_u32 s97, s23, 0
    s_mov_b32 s98, 2752512
    s_mov_b32 s99, 0x20000
    s_mov_b64 s[82:83], s[22:23]
    s_mov_b64 s[100:101], s[22:23]
    s_lshl_b32 s49, s33, 2
    s_add_u32 s49, s49, s3
    s_sub_u32 s49, s49, 14
    s_and_b32 s49, s49, 127
    s_cmp_eq_u32 s3, 15
    s_cbranch_scc0 L_s_h14b
    s_lshl_b32 s34, s49, 8
    s_add_u32 s34, s34, 65536
    s_add_u32 s56, s22, s34
    s_addc_u32 s57, s23, 0
    s_mov_b32 s35, 0
L_s_pl:
    s_add_u32 s35, s35, 1
    s_load_dwordx16 s[4:19], s[56:57], 0 glc
    s_load_dwordx8 s[24:31], s[56:57], 64 glc
    ds_read_b32 v18, v7 offset:18188
    s_waitcnt lgkmcnt(0)
    v_readfirstlane_b32 s48, v18
    s_nop 0
    s_cmp_lg_u32 s48, 0
    s_nop 2
    s_cbranch_scc1 L_s_hw
    s_mov_b32 s48, 0
    s_sub_u32 s40, s4, s64
    s_subb_u32 s41, s5, s65
    s_add_u32 s40, s40, 0x100000
    s_addc_u32 s41, s41, 0
    s_lshr_b32 s40, s40, 25
    s_or_b32 s40, s40, s41
    s_or_b32 s48, s48, s40
    s_sub_u32 s40, s6, s64
    s_subb_u32 s41, s7, s65
    s_add_u32 s40, s40, 0x100000
    s_addc_u32 s41, s41, 0
    s_lshr_b32 s40, s40, 25
    s_or_b32 s40, s40, s41
    s_or_b32 s48, s48, s40
    s_sub_u32 s40, s8, s64
    s_subb_u32 s41, s9, s65
    s_add_u32 s40, s40, 0x100000
    s_addc_u32 s41, s41, 0
    s_lshr_b32 s40, s40, 25
    s_or_b32 s40, s40, s41
    s_or_b32 s48, s48, s40
    s_sub_u32 s40, s10, s64
    s_subb_u32 s41, s11, s65
    s_add_u32 s40, s40, 0x100000
    s_addc_u32 s41, s41, 0
    s_lshr_b32 s40, s40, 25
    s_or_b32 s40, s40, s41
    s_or_b32 s48, s48, s40
    s_sub_u32 s40, s12, s64
    s_subb_u32 s41, s13, s65
    s_add_u32 s40, s40, 0x100000
    s_addc_u32 s41, s41, 0
    s_lshr_b32 s40, s40, 25
    s_or_b32 s40, s40, s41
    s_or_b32 s48, s48, s40
    s_sub_u32 s40, s14, s64
    s_subb_u32 s41, s15, s65
    s_add_u32 s40, s40, 0x100000
    s_addc_u32 s41, s41, 0
    s_lshr_b32 s40, s40, 25
    s_or_b32 s40, s40, s41
    s_or_b32 s48, s48, s40
    s_sub_u32 s40, s16, s64
    s_subb_u32 s41, s17, s65
    s_add_u32 s40, s40, 0x100000
    s_addc_u32 s41, s41, 0
    s_lshr_b32 s40, s40, 25
    s_or_b32 s40, s40, s41
    s_or_b32 s48, s48, s40
    s_sub_u32 s40, s18, s64
    s_subb_u32 s41, s19, s65
    s_add_u32 s40, s40, 0x100000
    s_addc_u32 s41, s41, 0
    s_lshr_b32 s40, s40, 25
    s_or_b32 s40, s40, s41
    s_or_b32 s48, s48, s40
    s_sub_u32 s40, s24, s64
    s_subb_u32 s41, s25, s65
    s_add_u32 s40, s40, 0x100000
    s_addc_u32 s41, s41, 0
    s_lshr_b32 s40, s40, 25
    s_or_b32 s40, s40, s41
    s_or_b32 s48, s48, s40
    s_sub_u32 s40, s26, s64
    s_subb_u32 s41, s27, s65
    s_add_u32 s40, s40, 0x100000
    s_addc_u32 s41, s41, 0
    s_lshr_b32 s40, s40, 25
    s_or_b32 s40, s40, s41
    s_or_b32 s48, s48, s40
    s_sub_u32 s40, s28, s64
    s_subb_u32 s41, s29, s65
    s_add_u32 s40, s40, 0x100000
    s_addc_u32 s41, s41, 0
    s_lshr_b32 s40, s40, 25
    s_or_b32 s40, s40, s41
    s_or_b32 s48, s48, s40
    s_sub_u32 s40, s30, s64
    s_subb_u32 s41, s31, s65
    s_add_u32 s40, s40, 0x100000
    s_addc_u32 s41, s41, 0
    s_lshr_b32 s40, s40, 25
    s_or_b32 s40, s40, s41
    s_or_b32 s48, s48, s40
    s_cmp_eq_u32 s48, 0
    s_cbranch_scc1 L_s_go
    s_cmp_gt_u32 s35, 0x40000
    s_cbranch_scc1 L_s_go
    s_branch L_s_pl
L_s_go:
    v_mov_b32 v20, s4
    v_mov_b32 v21, s5
    ds_write_b64 v7, v[20:21] offset:18192
    ds_write_b32 v7, v12 offset:18188
    s_branch L_s_hw
L_s_h14b:
    s_lshl_b32 s34, s49, 8
    s_add_u32 s34, s34, 65632
    s_add_u32 s56, s22, s34
    s_addc_u32 s57, s23, 0
    s_mov_b32 s35, 0
L_s2_pl:
    s_add_u32 s35, s35, 1
    s_load_dwordx16 s[4:19], s[56:57], 0 glc
    s_load_dwordx8 s[24:31], s[56:57], 64 glc
    s_waitcnt lgkmcnt(0)
    s_mov_b32 s48, 0
    s_sub_u32 s40, s4, s64
    s_subb_u32 s41, s5, s65
    s_add_u32 s40, s40, 0x100000
    s_addc_u32 s41, s41, 0
    s_lshr_b32 s40, s40, 25
    s_or_b32 s40, s40, s41
    s_or_b32 s48, s48, s40
    s_sub_u32 s40, s6, s64
    s_subb_u32 s41, s7, s65
    s_add_u32 s40, s40, 0x100000
    s_addc_u32 s41, s41, 0
    s_lshr_b32 s40, s40, 25
    s_or_b32 s40, s40, s41
    s_or_b32 s48, s48, s40
    s_sub_u32 s40, s8, s64
    s_subb_u32 s41, s9, s65
    s_add_u32 s40, s40, 0x100000
    s_addc_u32 s41, s41, 0
    s_lshr_b32 s40, s40, 25
    s_or_b32 s40, s40, s41
    s_or_b32 s48, s48, s40
    s_sub_u32 s40, s10, s64
    s_subb_u32 s41, s11, s65
    s_add_u32 s40, s40, 0x100000
    s_addc_u32 s41, s41, 0
    s_lshr_b32 s40, s40, 25
    s_or_b32 s40, s40, s41
    s_or_b32 s48, s48, s40
    s_sub_u32 s40, s12, s64
    s_subb_u32 s41, s13, s65
    s_add_u32 s40, s40, 0x100000
    s_addc_u32 s41, s41, 0
    s_lshr_b32 s40, s40, 25
    s_or_b32 s40, s40, s41
    s_or_b32 s48, s48, s40
    s_sub_u32 s40, s14, s64
    s_subb_u32 s41, s15, s65
    s_add_u32 s40, s40, 0x100000
    s_addc_u32 s41, s41, 0
    s_lshr_b32 s40, s40, 25
    s_or_b32 s40, s40, s41
    s_or_b32 s48, s48, s40
    s_sub_u32 s40, s16, s64
    s_subb_u32 s41, s17, s65
    s_add_u32 s40, s40, 0x100000
    s_addc_u32 s41, s41, 0
    s_lshr_b32 s40, s40, 25
    s_or_b32 s40, s40, s41
    s_or_b32 s48, s48, s40
    s_sub_u32 s40, s18, s64
    s_subb_u32 s41, s19, s65
    s_add_u32 s40, s40, 0x100000
    s_addc_u32 s41, s41, 0
    s_lshr_b32 s40, s40, 25
    s_or_b32 s40, s40, s41
    s_or_b32 s48, s48, s40
    s_sub_u32 s40, s24, s64
    s_subb_u32 s41, s25, s65
    s_add_u32 s40, s40, 0x100000
    s_addc_u32 s41, s41, 0
    s_lshr_b32 s40, s40, 25
    s_or_b32 s40, s40, s41
    s_or_b32 s48, s48, s40
    s_sub_u32 s40, s26, s64
    s_subb_u32 s41, s27, s65
    s_add_u32 s40, s40, 0x100000
    s_addc_u32 s41, s41, 0
    s_lshr_b32 s40, s40, 25
    s_or_b32 s40, s40, s41
    s_or_b32 s48, s48, s40
    s_sub_u32 s40, s28, s64
    s_subb_u32 s41, s29, s65
    s_add_u32 s40, s40, 0x100000
    s_addc_u32 s41, s41, 0
    s_lshr_b32 s40, s40, 25
    s_or_b32 s40, s40, s41
    s_or_b32 s48, s48, s40
    s_sub_u32 s40, s30, s64
    s_subb_u32 s41, s31, s65
    s_add_u32 s40, s40, 0x100000
    s_addc_u32 s41, s41, 0
    s_lshr_b32 s40, s40, 25
    s_or_b32 s40, s40, s41
    s_or_b32 s48, s48, s40
    s_cmp_eq_u32 s48, 0
    s_cbranch_scc1 L_s2_go
    s_cmp_gt_u32 s35, 0x40000
    s_cbranch_scc1 L_s2_go
    s_branch L_s2_pl
L_s2_go:
    s_cmp_lt_u32 s94, 2
    s_cselect_b32 s41, 6, 2
    s_sub_u32 s41, s95, s41
    s_cmp_ge_u32 s41, 24
    s_cbranch_scc1 L_s_nopf2
    s_mul_i32 s41, s41, 3072
    s_add_u32 s41, s41, 131072
    buffer_load_dwordx4 v[24:27], v8, s[36:39], s41 offen offset:0
    buffer_load_dwordx4 v[28:31], v8, s[36:39], s41 offen offset:1024
    buffer_load_dwordx4 v[32:35], v8, s[36:39], s41 offen offset:2048
L_s_nopf2:
    ds_write_b32 v7, v12 offset:18184
L_s_hw:
    s_mov_b32 s62, 0
L_sp9:
    ds_read_b32 v18, v7 offset:18184
    s_add_u32 s62, s62, 1
    s_waitcnt lgkmcnt(0)
    v_readfirstlane_b32 s60, v18
    s_nop 0
    s_cmp_ge_u32 s60, 1
    s_nop 2
    s_cbranch_scc1 L_sp9_d
    s_cmp_gt_u32 s62, 0x1000000
    s_cbranch_scc1 L_sp9_d
    s_sleep 1
    s_branch L_sp9
L_sp9_d:
    s_mov_b32 s62, 0
L_sp10:
    ds_read_b32 v18, v7 offset:18180
    s_add_u32 s62, s62, 1
    s_waitcnt lgkmcnt(0)
    v_readfirstlane_b32 s60, v18
    s_nop 0
    s_cmp_ge_u32 s60, 11
    s_nop 2
    s_cbranch_scc1 L_sp10_d
    s_cmp_gt_u32 s62, 0x1000000
    s_cbranch_scc1 L_sp10_d
    s_sleep 1
    s_branch L_sp10
L_sp10_d:
    s_mul_i32 s50, s89, 6144
    s_add_u32 s50, s50, 131072
    buffer_load_dwordx4 v[44:47], v8, s[36:39], s50 offen offset:0
    buffer_load_dwordx4 v[48:51], v8, s[36:39], s50 offen offset:1024
    buffer_load_dwordx4 v[52:55], v8, s[36:39], s50 offen offset:2048
    buffer_load_dwordx4 v[56:59], v8, s[36:39], s50 offen offset:3072
    s_add_u32 s50, s50, 4096
    buffer_load_dwordx4 v[60:63], v8, s[36:39], s50 offen offset:0
    buffer_load_dwordx4 v[64:67], v8, s[36:39], s50 offen offset:1024
    s_mov_b32 s54, 1
    s_waitcnt vmcnt(6)
    s_branch L_pv
L_prod:
    s_mov_b32 s33, s95
    s_mov_b32 s32, s94
    v_lshlrev_b32 v4, 3, v1
    s_mul_i32 s40, s3, 384
    v_lshrrev_b32 v12, 3, v1
    v_and_b32 v13, 7, v1
    v_and_b32 v14, 2, v12
    v_xor_b32 v13, v13, v14
    s_and_b32 s41, s3, 1
    s_lshl_b32 s41, s41, 2
    v_xor_b32 v13, s41, v13
    v_mul_u32_u24 v12, 384, v12
    v_lshl_add_u32 v10, v13, 4, v12
    v_lshrrev_b32 v12, 4, v1
    v_bfe_u32 v13, v1, 2, 2
    v_lshl_add_u32 v14, v12, 3, v13
    v_lshlrev_b32 v2, 7, v14
    v_and_b32 v14, 2, v13
    v_and_b32 v12, 1, v12
    v_lshl_or_b32 v14, v12, 2, v14
    v_bfe_u32 v12, v1, 1, 1
    s_and_b32 s73, s3, 3
    s_lshl_b32 s73, s73, 1
    v_add_u32 v12, s73, v12
    v_xor_b32 v12, v12, v14
    v_lshl_add_u32 v2, v12, 4, v2
    v_and_b32 v12, 1, v1
    v_lshl_add_u32 v2, v12, 3, v2
    s_lshr_b32 s73, s3, 2
    s_mul_i32 s73, s73, 12288
    s_add_u32 s73, s73, 12288
    v_add_u32 v2, s73, v2
    v_lshrrev_b32 v12, 5, v1
    v_lshlrev_b32 v3, 8, v12
    v_and_b32 v12, 15, v1
    v_lshl_add_u32 v3, v12, 4, v3
    v_bfe_u32 v12, v1, 4, 1
    v_lshl_add_u32 v3, v12, 3, v3
    s_lshl_b32 s73, s3, 9
    s_add_u32 s73, s73, 6144
    v_add_u32 v3, s73, v3
    v_lshrrev_b32 v5, 1, v1
    v_lshlrev_b32 v5, 8, v5
    v_and_b32 v6, 1, v1
    v_lshl_add_u32 v5, v6, 3, v5
    s_lshl_b32 s41, s3, 4
    v_add_u32 v5, s41, v5
    v_lshlrev_b32 v8, 4, v1
    v_and_b32 v6, 15, v1
    v_lshrrev_b32 v7, 4, v1
    v_mul_u32_u24 v9, 384, v6
    v_lshl_add_u32 v9, v7, 4, v9
    s_waitcnt lgkmcnt(0)
    s_mov_b32 s28, s4
    s_mov_b32 s29, s5
    s_mov_b32 s30, 6144
    s_mov_b32 s31, 0x20000
    s_mov_b32 s36, s22
    s_mov_b32 s37, s23
    s_mov_b32 s38, 1048576
    s_mov_b32 s39, 0x20000
    v_mov_b32 v20, 0
    v_mov_b32 v21, 0
    s_mov_b32 exec_hi, 0xffff
    buffer_load_dwordx2 v[20:21], v4, s[28:31], s40 offen
    s_mov_b64 exec, -1
    s_cmp_ge_u32 s3, 12
    s_cbranch_scc1 L_p_hi0
    s_mov_b32 s24, s10
    s_mov_b32 s25, s11
    s_mov_b32 s26, 73728
    s_mov_b32 s27, 0x20000
    s_mul_i32 s70, s32, 36864
    s_mul_i32 s71, s3, 3072
    s_add_u32 s70, s70, s71
    s_lshl_b32 s71, s3, 10
    s_add_u32 s71, s71, 12288
    s_add_u32 m0, s71, 0
    s_add_u32 s72, s70, 0
    buffer_load_dwordx4 v10, s[24:27], s72 offen lds
    s_add_u32 m0, s71, 12288
    s_add_u32 s72, s70, 128
    buffer_load_dwordx4 v10, s[24:27], s72 offen lds
    s_add_u32 m0, s71, 24576
    s_add_u32 s72, s70, 256
    buffer_load_dwordx4 v10, s[24:27], s72 offen lds
    s_waitcnt vmcnt(3)
    s_branch L_p_ln
L_p_hi0:
    s_sub_u32 s43, s3, 13
    s_cmp_lt_u32 s43, 2
    s_cbranch_scc0 L_p_nowk
    s_mov_b32 s24, s12
    s_mov_b32 s25, s13
    s_mov_b32 s26, 73728
    s_mov_b32 s27, 0x20000
    s_lshl_b32 s44, s33, 1
    s_add_u32 s44, s44, s43
    s_mul_i32 s42, s44, 6144
    buffer_load_dwordx4 v[44:47], v9, s[24:27], s42 offen offset:0
    buffer_load_dwordx4 v[48:51], v9, s[24:27], s42 offen offset:64
    buffer_load_dwordx4 v[52:55], v9, s[24:27], s42 offen offset:128
    buffer_load_dwordx4 v[56:59], v9, s[24:27], s42 offen offset:192
    buffer_load_dwordx4 v[60:63], v9, s[24:27], s42 offen offset:256
    buffer_load_dwordx4 v[64:67], v9, s[24:27], s42 offen offset:320
    s_waitcnt vmcnt(6)
    s_branch L_p_ln
L_p_nowk:
    s_waitcnt vmcnt(0)
L_p_ln:
    v_lshlrev_b32 v22, 16, v20
    v_and_b32 v23, 0xffff0000, v20
    v_lshlrev_b32 v24, 16, v21
    v_and_b32 v25, 0xffff0000, v21
    v_add_f32 v26, v22, v23
    v_add_f32 v27, v24, v25
    v_add_f32 v26, v26, v27
    s_nop 1
    v_add_f32_dpp v26, v26, v26 quad_perm:[1,0,3,2] row_mask:0xf bank_mask:0xf
    s_nop 1
    v_add_f32_dpp v26, v26, v26 quad_perm:[2,3,0,1] row_mask:0xf bank_mask:0xf
    s_nop 1
    v_add_f32_dpp v26, v26, v26 row_half_mirror row_mask:0xf bank_mask:0xf
    s_nop 1
    v_add_f32_dpp v26, v26, v26 row_mirror row_mask:0xf bank_mask:0xf
    v_mov_b32 v27, v26
    s_nop 1
    v_permlane16_swap_b32 v26, v27
    v_add_f32 v26, v26, v27
    v_mov_b32 v27, v26
    s_nop 1
    v_permlane32_swap_b32 v26, v27
    v_add_f32 v26, v26, v27
    v_mul_f32 v26, 0x3baaaaab, v26
    v_sub_f32 v22, v22, v26
    v_sub_f32 v23, v23, v26
    v_sub_f32 v24, v24, v26
    v_sub_f32 v25, v25, v26
    v_mul_f32 v27, v22, v22
    v_fmac_f32 v27, v23, v23
    v_fmac_f32 v27, v24, v24
    v_fmac_f32 v27, v25, v25
    v_cmp_gt_u32 vcc, 48, v1
    s_nop 1
    v_cndmask_b32 v27, 0, v27, vcc
    s_nop 1
    v_add_f32_dpp v27, v27, v27 quad_perm:[1,0,3,2] row_mask:0xf bank_mask:0xf
    s_nop 1
    v_add_f32_dpp v27, v27, v27 quad_perm:[2,3,0,1] row_mask:0xf bank_mask:0xf
    s_nop 1
    v_add_f32_dpp v27, v27, v27 row_half_mirror row_mask:0xf bank_mask:0xf
    s_nop 1
    v_add_f32_dpp v27, v27, v27 row_mirror row_mask:0xf bank_mask:0xf
    v_mov_b32 v28, v27
    s_nop 1
    v_permlane16_swap_b32 v27, v28
    v_add_f32 v27, v27, v28
    v_mov_b32 v28, v27
    s_nop 1
    v_permlane32_swap_b32 v27, v28
    v_add_f32 v27, v27, v28
    v_mov_b32 v28, 0x3727c5ac
    v_mov_b32 v29, 0x3baaaaab
    v_fmac_f32 v28, v27, v29
    v_rsq_f32 v28, v28
    s_nop 0
    v_mul_f32 v22, v22, v28
    v_mul_f32 v23, v23, v28
    v_mul_f32 v24, v24, v28
    v_mul_f32 v25, v25, v28
    v_cvt_pk_bf16_f32 v20, v22, v23
    v_cvt_pk_bf16_f32 v21, v24, v25
    s_mov_b32 exec_hi, 0xffff
    ds_write_b64 v5, v[20:21] offset:0
    s_mov_b64 exec, -1
    s_cmp_ge_u32 s3, 12
    s_cbranch_scc1 L_p_hi
    s_mul_i32 s45, s32, 3072
    v_add_u32 v11, s45, v8
    s_waitcnt vmcnt(0) lgkmcnt(0)
    s_barrier
    ds_read_b128 v[20:23], v11 offset:0
    ds_read_b64_tr_b16 v[44:45], v2 offset:0
    ds_read_b64_tr_b16 v[46:47], v2 offset:512
    ds_read_b128 v[24:27], v11 offset:1024
    ds_read_b64_tr_b16 v[48:49], v2 offset:4096
    ds_read_b64_tr_b16 v[50:51], v2 offset:4608
    ds_read_b128 v[28:31], v11 offset:2048
    ds_read_b64_tr_b16 v[52:53], v2 offset:8192
    ds_read_b64_tr_b16 v[54:55], v2 offset:8704
    s_waitcnt lgkmcnt(6)
    v_mfma_f32_16x16x32_bf16 v[68:71], v[44:47], v[20:23], 0
    s_waitcnt lgkmcnt(3)
    v_mfma_f32_16x16x32_bf16 v[68:71], v[48:51], v[24:27], v[68:71]
    s_waitcnt lgkmcnt(0)
    v_mfma_f32_16x16x32_bf16 v[68:71], v[52:55], v[28:31], v[68:71]
    s_nop 7
    v_cvt_pk_bf16_f32 v72, v68, v69
    v_cvt_pk_bf16_f32 v73, v70, v71
    ds_write_b64 v3, v[72:73]
    s_waitcnt lgkmcnt(0)
    s_barrier
    s_endpgm
L_p_hi:
    s_waitcnt lgkmcnt(0)
    s_sub_u32 s43, s3, 13
    s_cmp_lt_u32 s43, 2
    s_cbranch_scc1 L_p_s2
    s_barrier
    s_endpgm
L_p_s2:
    s_lshl_b32 s44, s33, 1
    s_add_u32 s44, s44, s43
    s_mul_i32 s45, s32, 6144
    v_lshrrev_b32 v12, 5, v1
    v_lshlrev_b32 v3, 8, v12
    v_and_b32 v12, 15, v1
    v_lshl_add_u32 v3, v12, 4, v3
    v_bfe_u32 v12, v1, 4, 1
    v_lshl_add_u32 v3, v12, 3, v3
    s_lshl_b32 s73, s44, 9
    v_add_u32 v3, s73, v3
    v_add_u32 v3, s45, v3
    v_lshlrev_b32 v9, 8, v1
    s_lshl_b32 s41, s95, 1
    s_add_u32 s41, s41, s94
    s_lshl_b32 s41, s41, 3
    s_add_u32 s41, s41, 65536
    v_add_u32 v9, s41, v9
    s_mov_b32 s42, 0x3dd53b95
    s_barrier
    s_barrier
    ds_read_b128 v[20:23], v8 offset:6144
    ds_read_b128 v[24:27], v8 offset:7168
    ds_read_b128 v[28:31], v8 offset:8192
    ds_read_b128 v[32:35], v8 offset:9216
    ds_read_b128 v[36:39], v8 offset:10240
    ds_read_b128 v[40:43], v8 offset:11264
    s_waitcnt vmcnt(0)
    s_waitcnt lgkmcnt(5)
    v_mfma_f32_16x16x32_bf16 v[68:71], v[44:47], v[20:23], 0
    s_waitcnt lgkmcnt(4)
    v_mfma_f32_16x16x32_bf16 v[68:71], v[48:51], v[24:27], v[68:71]
    s_waitcnt lgkmcnt(3)
    v_mfma_f32_16x16x32_bf16 v[68:71], v[52:55], v[28:31], v[68:71]
    s_waitcnt lgkmcnt(2)
    v_mfma_f32_16x16x32_bf16 v[68:71], v[56:59], v[32:35], v[68:71]
    s_waitcnt lgkmcnt(1)
    v_mfma_f32_16x16x32_bf16 v[68:71], v[60:63], v[36:39], v[68:71]
    s_waitcnt lgkmcnt(0)
    v_mfma_f32_16x16x32_bf16 v[68:71], v[64:67], v[40:43], v[68:71]
    s_nop 7
    v_mul_f32 v68, s42, v68
    v_mul_f32 v69, s42, v69
    v_mul_f32 v70, s42, v70
    v_mul_f32 v71, s42, v71
    v_cvt_pk_bf16_f32 v72, v68, v69
    v_cvt_pk_bf16_f32 v73, v70, v71
    buffer_store_dwordx2 v[72:73], v3, s[36:39], 0 offen sc0 sc1
    s_waitcnt vmcnt(0)
    s_barrier
    s_cmp_eq_u32 s3, 13
    s_cbranch_scc0 L_p_end
    s_memrealtime s[44:45]
    s_waitcnt lgkmcnt(0)
    v_mov_b32 v72, s44
    v_mov_b32 v73, s45
    s_mov_b32 s46, 16384
    buffer_store_dwordx2 v[72:73], v9, s[36:39], 0 offen sc0 sc1
    buffer_store_dwordx2 v[72:73], v9, s[36:39], s46 offen sc0 sc1
    s_nop 1
L_p_end:
    s_endpgm
L_wvo:
    s_mul_i32 s33, s95, 6
    s_add_u32 s33, s33, s94
    s_sub_u32 s33, s33, 2
    s_mul_i32 s32, s33, 43
    s_lshr_b32 s32, s32, 7
    s_mul_i32 s34, s32, 3
    s_sub_u32 s34, s33, s34
    s_cmp_ge_u32 s3, 12
    s_cbranch_scc1 L_v_end
    v_lshrrev_b32 v12, 3, v1
    v_and_b32 v13, 7, v1
    v_and_b32 v14, 2, v12
    v_xor_b32 v14, v13, v14
    v_mul_u32_u24 v15, 384, v12
    v_lshl_add_u32 v10, v14, 4, v15
    v_xor_b32 v14, 4, v14
    v_lshl_add_u32 v11, v14, 4, v15
    v_and_b32 v14, 6, v12
    v_xor_b32 v14, v13, v14
    v_lshl_add_u32 v9, v14, 4, v15
    v_lshrrev_b32 v12, 4, v1
    v_bfe_u32 v13, v1, 2, 2
    v_lshl_add_u32 v14, v12, 3, v13
    v_lshlrev_b32 v2, 7, v14
    v_and_b32 v14, 2, v13
    v_and_b32 v15, 1, v12
    v_lshl_or_b32 v14, v15, 2, v14
    v_bfe_u32 v15, v1, 1, 1
    s_and_b32 s40, s3, 3
    s_lshl_b32 s40, s40, 1
    v_add_u32 v15, s40, v15
    v_xor_b32 v15, v15, v14
    v_lshl_add_u32 v2, v15, 4, v2
    v_and_b32 v15, 1, v1
    v_lshl_add_u32 v2, v15, 3, v2
    v_and_b32 v13, 15, v1
    v_lshlrev_b32 v14, 7, v13
    v_and_b32 v15, 2, v13
    v_xor_b32 v15, v15, v12
    v_lshl_add_u32 v14, v15, 4, v14
    s_lshr_b32 s41, s3, 2
    s_lshl_b32 s42, s41, 11
    s_add_u32 s42, s42, 24576
    v_add_u32 v14, s42, v14
    v_and_b32 v15, 4, v13
    v_lshlrev_b32 v15, 4, v15
    v_add_u32 v4, v14, v15
    v_xor_b32 v15, 64, v15
    v_add_u32 v5, v14, v15
    s_mul_i32 s43, s32, 3
    s_add_u32 s43, s43, s41
    v_lshrrev_b32 v12, 5, v1
    v_lshlrev_b32 v3, 8, v12
    v_and_b32 v12, 15, v1
    v_lshl_add_u32 v3, v12, 4, v3
    v_bfe_u32 v12, v1, 4, 1
    v_lshl_add_u32 v3, v12, 3, v3
    s_lshl_b32 s73, s43, 9
    s_add_u32 s73, s73, 131072
    v_add_u32 v3, s73, v3
    s_lshl_b32 s44, s34, 2
    s_and_b32 s45, s3, 3
    s_add_u32 s44, s44, s45
    s_mul_i32 s44, s44, 6144
    v_add_u32 v3, s44, v3
    v_lshlrev_b32 v6, 8, v1
    s_lshl_b32 s45, s33, 3
    s_add_u32 s45, s45, 65632
    v_add_u32 v6, s45, v6
    s_waitcnt lgkmcnt(0)
    s_mov_b32 s24, s16
    s_mov_b32 s25, s17
    s_mov_b32 s26, 73728
    s_mov_b32 s27, 0x20000
    s_mov_b32 s28, s14
    s_mov_b32 s29, s15
    s_mov_b32 s30, 73728
    s_mov_b32 s31, 0x20000
    s_mov_b32 s36, s22
    s_mov_b32 s37, s23
    s_mov_b32 s38, 1048576
    s_mov_b32 s39, 0x20000
    s_cmp_ge_u32 s3, 6
    s_cbranch_scc1 L_v_nowv
    s_mul_i32 s46, s32, 18432
    s_mul_i32 s47, s3, 3072
    s_add_u32 s46, s46, s47
    s_lshl_b32 s47, s3, 10
    s_add_u32 s47, s47, 24576
    s_add_u32 m0, s47, 0
    s_add_u32 s48, s46, 0
    buffer_load_dwordx4 v9, s[28:31], s48 offen lds
    s_add_u32 m0, s47, 6144
    s_add_u32 s48, s46, 128
    buffer_load_dwordx4 v9, s[28:31], s48 offen lds
    s_add_u32 m0, s47, 12288
    s_add_u32 s48, s46, 256
    buffer_load_dwordx4 v9, s[28:31], s48 offen lds
L_v_nowv:
    s_mul_i32 s46, s3, 6144
    s_lshl_b32 s47, s34, 7
    s_add_u32 s46, s46, s47
    s_lshl_b32 s47, s3, 11
    s_add_u32 m0, s47, 0
    s_add_u32 s48, s46, 0
    buffer_load_dwordx4 v10, s[24:27], s48 offen lds
    s_add_u32 m0, s47, 1024
    s_add_u32 s48, s46, 3072
    buffer_load_dwordx4 v11, s[24:27], s48 offen lds
    s_waitcnt vmcnt(0)
    s_barrier
    ds_read_b128 v[20:23], v4 offset:0
    ds_read_b64_tr_b16 v[44:45], v2 offset:0
    ds_read_b64_tr_b16 v[46:47], v2 offset:512
    ds_read_b128 v[24:27], v5 offset:0
    ds_read_b64_tr_b16 v[48:49], v2 offset:4096
    ds_read_b64_tr_b16 v[50:51], v2 offset:4608
    ds_read_b128 v[28:31], v4 offset:6144
    ds_read_b64_tr_b16 v[52:53], v2 offset:8192
    ds_read_b64_tr_b16 v[54:55], v2 offset:8704
    ds_read_b128 v[32:35], v5 offset:6144
    ds_read_b64_tr_b16 v[56:57], v2 offset:12288
    ds_read_b64_tr_b16 v[58:59], v2 offset:12800
    s_waitcnt lgkmcnt(6)
    ds_read_b128 v[36:39], v4 offset:12288
    ds_read_b64_tr_b16 v[60:61], v2 offset:16384
    ds_read_b64_tr_b16 v[62:63], v2 offset:16896
    ds_read_b128 v[40:43], v5 offset:12288
    ds_read_b64_tr_b16 v[64:65], v2 offset:20480
    ds_read_b64_tr_b16 v[66:67], v2 offset:20992
    s_waitcnt lgkmcnt(0)
    v_mfma_f32_16x16x32_bf16 v[68:71], v[20:23], v[44:47], 0
    v_mfma_f32_16x16x32_bf16 v[68:71], v[24:27], v[48:51], v[68:71]
    v_mfma_f32_16x16x32_bf16 v[68:71], v[28:31], v[52:55], v[68:71]
    v_mfma_f32_16x16x32_bf16 v[68:71], v[32:35], v[56:59], v[68:71]
    v_mfma_f32_16x16x32_bf16 v[68:71], v[36:39], v[60:63], v[68:71]
    v_mfma_f32_16x16x32_bf16 v[68:71], v[40:43], v[64:67], v[68:71]
    s_nop 7
    v_cvt_pk_bf16_f32 v72, v68, v69
    v_cvt_pk_bf16_f32 v73, v70, v71
    buffer_store_dwordx2 v[72:73], v3, s[36:39], 0 offen sc0 sc1
    s_waitcnt vmcnt(0)
    s_barrier
    s_cmp_lg_u32 s3, 0
    s_cbranch_scc1 L_v_end
    s_memrealtime s[44:45]
    s_waitcnt lgkmcnt(0)
    v_mov_b32 v72, s44
    v_mov_b32 v73, s45
    s_mov_b32 s46, 16384
    buffer_store_dwordx2 v[72:73], v6, s[36:39], 0 offen sc0 sc1
    buffer_store_dwordx2 v[72:73], v6, s[36:39], s46 offen sc0 sc1
    s_nop 1
L_v_end:
    s_endpgm
L_main_end:
    s_endpgm
.section .rodata,"a"
.p2align 6
.amdhsa_kernel standalone__detection_seg_dino__vision_kernel
  .amdhsa_next_free_vgpr 128
  .amdhsa_next_free_sgpr 102
  .amdhsa_accum_offset 128
  .amdhsa_group_segment_fixed_size 0
  .amdhsa_kernarg_size 80
  .amdhsa_user_sgpr_count 2
  .amdhsa_user_sgpr_kernarg_segment_ptr 1
  .amdhsa_system_sgpr_workgroup_id_x 1
  .amdhsa_float_denorm_mode_32 3
.end_amdhsa_kernel
.text
```
